```python
import torch

def _softmax(x, axis=-1):
    return torch.softmax(x, dim=axis)
def _gelu(x):
    return torch.nn.functional.gelu(x, approximate="tanh")
def _silu(x):
    return torch.nn.functional.silu(x)
def _sigmoid(x):
    return torch.sigmoid(x)
def _layernorm(x, axis=-1, eps=1e-5):
    m = x.mean(dim=axis, keepdim=True)
    v = x.var(dim=axis, keepdim=True, unbiased=False)
    return (x - m) / torch.sqrt(v + eps)
def _scatter_add(tgt, idx, src, axis=0):
    return tgt.clone().index_add_(axis, idx, src)
def _segment_sum(src, seg, n):
    out = torch.zeros((n,) + src.shape[1:], dtype=src.dtype)
    return out.index_add_(0, seg, src)
def _pad(x, pw):
    flat = tuple(v for pair in reversed(pw) for v in pair)
    return torch.nn.functional.pad(x, flat)

kernel_name = 'standalone__gqa_softmax__near_ridge'

def setup_inputs():

    _w = (lambda a: (lambda t: t.to(torch.bfloat16) if t.is_floating_point() else t)(torch.as_tensor(a)))
    B, Hq, Hkv, Sq, Sk, D = 8, 32, 4, 80, 1024, 128
    return {
        "q": _w((lambda *s: torch.randn(*s, dtype=torch.bfloat16) * 0.8)(B, Hq, Sq, D)),
        "k": _w((lambda *s: torch.randn(*s, dtype=torch.bfloat16) * 0.8)(B, Hkv, Sk, D)),
        "v": _w((lambda *s: torch.randn(*s, dtype=torch.bfloat16) * 0.05)(B, Hkv, Sk, D)),
    }

def reference(q, k, v):
    B, Hq, Sq, D = q.shape
    Hkv = k.shape[1]
    rep = Hq // Hkv
    k = (lambda x, n, axis: torch.repeat_interleave(x, n, dim=axis))(k, rep, axis=1)
    v = (lambda x, n, axis: torch.repeat_interleave(x, n, dim=axis))(v, rep, axis=1)
    scale = D ** -0.5
    scores = torch.einsum("bhqd,bhkd->bhqk", q, k) * scale
    p = _softmax(scores, axis=-1)
    return torch.einsum("bhqk,bhkd->bhqd", p, v)
```

```asm
; @launch grid=(256,1,1) block=(256,1,1) lds=153600
.amdgcn_target "amdgcn-amd-amdhsa--gfx950"
.text
.globl standalone__gqa_softmax__near_ridge_kernel
.p2align 12
.p2align 8
.type standalone__gqa_softmax__near_ridge_kernel,@function
standalone__gqa_softmax__near_ridge_kernel:
    s_cmp_ge_u32 s2, 0x100
    s_cbranch_scc1 L_end
    s_load_dwordx2 s[12:13], s[0:1], 0
    s_load_dwordx2 s[16:17], s[0:1], 8
    s_load_dwordx2 s[20:21], s[0:1], 16
    s_load_dwordx2 s[24:25], s[0:1], 24
    s_getpc_b64 s[6:7]
    v_and_b32 v109, 7, v0
    s_bfe_u32 s62, s2, 0x40003
    s_min_u32 s62, s62, 14
    s_lshl_b32 s62, s62, 10
    v_lshl_add_u32 v109, v109, 7, s62
    global_load_dword v111, v109, s[6:7]
    v_lshrrev_b32 v108, 6, v0
    v_and_b32 v104, 63, v0
    v_readfirstlane_b32 s28, v108
    s_mov_b32 s14, 0x500000
    s_mov_b32 s15, 0x20000
    s_mov_b32 s18, 0x800000
    s_mov_b32 s19, 0x20000
    s_mov_b32 s22, 0x800000
    s_mov_b32 s23, 0x20000
    s_mov_b32 s26, 0x500000
    s_mov_b32 s27, 0x20000
    s_and_b32 s29, s2, 7
    s_lshl_b32 s29, s29, 2
    s_bfe_u32 s62, s2, 0x20003
    s_add_u32 s29, s29, s62
    s_lshr_b32 s63, s2, 5
    s_xor_b32 s63, s63, 7
    s_lshl_b32 s30, s29, 3
    s_add_u32 s30, s30, s63
    s_mul_i32 s52, s30, 20480
    s_add_u32 s53, s52, 4096
    s_add_u32 s54, s52, 8192
    s_add_u32 s55, s52, 12288
    s_add_u32 s56, s52, 16384
    v_lshlrev_b32 v169, 4, v0
    s_lshl_b32 s31, s28, 15
    v_lshlrev_b32 v107, 4, v104
    v_lshrrev_b32 v105, 4, v104
    v_and_b32 v106, 15, v104
    v_xor_b32 v108, v106, v105
    v_lshlrev_b32 v108, 4, v108
    v_lshl_or_b32 v16, v105, 8, v108
    v_xor_b32 v17, 64, v16
    v_xor_b32 v18, 128, v16
    v_xor_b32 v19, 192, v16
    s_mov_b32 s57, 0x76543210
    s_cmp_ge_u32 s63, 2
    s_cselect_b32 s57, 0x67543210, s57
    s_cmp_ge_u32 s63, 3
    s_cselect_b32 s57, 0x75643210, s57
    s_cmp_ge_u32 s63, 4
    s_cselect_b32 s57, 0x76453201, s57
    s_cmp_ge_u32 s63, 5
    s_cselect_b32 s57, 0x76534201, s57
    s_cmp_ge_u32 s63, 6
    s_cselect_b32 s57, 0x76542301, s57
    s_cmp_ge_u32 s63, 7
    s_cselect_b32 s57, 0x76543021, s57
    s_lshl_b32 s35, s29, 18
    s_lshl_b32 s34, s28, 16
    s_add_u32 s35, s35, s34
    s_bfe_u32 s62, s57, 0x30000
    s_lshl_b32 s62, s62, 13
    s_add_u32 s36, s35, s62
    s_add_u32 s37, s36, 4096
    s_bfe_u32 s62, s57, 0x30004
    s_lshl_b32 s62, s62, 13
    s_add_u32 s38, s35, s62
    s_add_u32 s39, s38, 4096
    v_lshlrev_b32 v108, 2, v105
    v_xor_b32 v108, v108, v106
    v_lshlrev_b32 v108, 4, v108
    v_lshl_or_b32 v20, v105, 8, v108
    v_xor_b32 v21, 32, v20
    s_mov_b32 m0, s31
    s_waitcnt lgkmcnt(0)
    buffer_load_dwordx4 v[136:139], v169, s[12:15], s52 offen
    s_barrier
    buffer_load_dwordx4 v[140:143], v169, s[12:15], s53 offen
    s_barrier
    buffer_load_dwordx4 v[144:147], v169, s[12:15], s54 offen
    s_barrier
    buffer_load_dwordx4 v16, s[16:19], s36 offen lds
    s_barrier
    buffer_load_dwordx4 v17, s[16:19], s36 offen offset:1024 lds
    s_barrier
    buffer_load_dwordx4 v18, s[16:19], s36 offen offset:2048 lds
    s_barrier
    buffer_load_dwordx4 v19, s[16:19], s36 offen offset:3072 lds
    s_barrier
    buffer_load_dwordx4 v[148:151], v169, s[12:15], s55 offen
    s_barrier
    buffer_load_dwordx4 v[152:155], v169, s[12:15], s56 offen
    s_add_u32 m0, s31, 4096
    s_barrier
    buffer_load_dwordx4 v16, s[16:19], s37 offen lds
    buffer_load_dwordx4 v17, s[16:19], s37 offen offset:1024 lds
    s_bfe_u32 s62, s57, 0x30008
    s_lshl_b32 s62, s62, 13
    s_add_u32 s40, s35, s62
    s_add_u32 s41, s40, 4096
    s_bfe_u32 s62, s57, 0x3000c
    s_lshl_b32 s62, s62, 13
    s_add_u32 s42, s35, s62
    s_add_u32 s43, s42, 4096
    s_bfe_u32 s62, s57, 0x30010
    s_lshl_b32 s62, s62, 13
    s_add_u32 s44, s35, s62
    s_add_u32 s45, s44, 4096
    s_bfe_u32 s62, s57, 0x30014
    s_lshl_b32 s62, s62, 13
    s_add_u32 s46, s35, s62
    s_add_u32 s47, s46, 4096
    s_bfe_u32 s62, s57, 0x30018
    s_lshl_b32 s62, s62, 13
    s_add_u32 s48, s35, s62
    s_add_u32 s49, s48, 4096
    s_bfe_u32 s62, s57, 0x3001c
    s_lshl_b32 s62, s62, 13
    s_add_u32 s50, s35, s62
    s_add_u32 s51, s50, 4096
    s_mov_b32 s58, 0x3e0293ee
    s_mov_b32 s59, s58
    s_mov_b32 s60, 0
    s_mov_b32 s61, 0x4b800000
    v_xor_b32 v108, v106, v105
    v_lshlrev_b32 v108, 4, v108
    v_lshl_or_b32 v108, v106, 8, v108
    v_xor_b32 v109, 0, v108
    v_add_u32 v4, s31, v109
    v_xor_b32 v109, 64, v108
    v_add_u32 v5, s31, v109
    v_xor_b32 v109, 128, v108
    v_add_u32 v6, s31, v109
    v_xor_b32 v109, 192, v108
    v_add_u32 v7, s31, v109
    v_bfe_u32 v108, v104, 2, 2
    v_lshlrev_b32 v109, 2, v108
    v_and_b32 v110, 1, v105
    v_lshl_or_b32 v109, v110, 1, v109
    v_bfe_u32 v110, v104, 1, 1
    v_xor_b32 v109, v109, v110
    v_lshlrev_b32 v109, 4, v109
    v_lshrrev_b32 v110, 2, v104
    v_lshl_or_b32 v109, v110, 8, v109
    v_and_b32 v110, 1, v104
    v_lshl_or_b32 v109, v110, 3, v109
    v_add_u32 v109, s31, v109
    s_lshl_b32 s62, s28, 6
    v_xor_b32 v8, s62, v109
    s_add_u32 s62, s62, 32
    s_and_b32 s62, s62, 0xff
    v_xor_b32 v9, s62, v109
    s_add_u32 s62, s62, 32
    s_and_b32 s62, s62, 0xff
    v_xor_b32 v10, s62, v109
    s_add_u32 s62, s62, 32
    s_and_b32 s62, s62, 0xff
    v_xor_b32 v11, s62, v109
    s_add_u32 s62, s62, 32
    s_and_b32 s62, s62, 0xff
    v_xor_b32 v12, s62, v109
    s_add_u32 s62, s62, 32
    s_and_b32 s62, s62, 0xff
    v_xor_b32 v13, s62, v109
    s_add_u32 s62, s62, 32
    s_and_b32 s62, s62, 0xff
    v_xor_b32 v14, s62, v109
    s_add_u32 s62, s62, 32
    s_and_b32 s62, s62, 0xff
    v_xor_b32 v15, s62, v109
    v_lshlrev_b32 v108, 2, v106
    v_add_u32 v22, 151552, v108
    v_lshlrev_b32 v108, 4, v106
    v_add_u32 v23, 152064, v108
    s_lshl_b32 s62, s28, 2
    v_add_u32 v24, s62, v23
    v_and_b32 v108, 1, v105
    v_lshrrev_b32 v109, 1, v105
    v_lshl_or_b32 v108, v108, 1, v109
    v_lshlrev_b32 v108, 4, v108
    v_lshl_or_b32 v108, v106, 8, v108
    s_lshl_b32 s62, s28, 6
    v_add_u32 v29, s62, v108
    v_add_u32 v25, s31, v107
    s_sub_u32 s62, s28, 1
    s_and_b32 s62, s62, 3
    s_lshl_b32 s62, s62, 15
    v_add_u32 v26, s62, v107
    s_sub_u32 s62, s28, 2
    s_and_b32 s62, s62, 3
    s_lshl_b32 s62, s62, 15
    v_add_u32 v27, s62, v107
    s_sub_u32 s62, s28, 3
    s_and_b32 s62, s62, 3
    s_lshl_b32 s62, s62, 15
    v_add_u32 v28, s62, v107
    v_mov_b32 v108, 0xff800000
    ds_write_b32 v22, v108 offset:0
    ds_write_b32 v22, v108 offset:64
    ds_write_b32 v22, v108 offset:128
    ds_write_b32 v22, v108 offset:192
    ds_write_b32 v22, v108 offset:256
    v_mov_b32 v108, 0x3f803f80
    v_accvgpr_write_b32 a196, v108
    v_accvgpr_write_b32 a197, v108
    v_accvgpr_write_b32 a198, v108
    v_accvgpr_write_b32 a199, v108
    v_accvgpr_write_b32 a200, 0
    v_accvgpr_write_b32 a201, 0
    v_accvgpr_write_b32 a204, 0
    v_accvgpr_write_b32 a205, 0
    v_and_b32 v108, 1, v104
    v_lshlrev_b32 v108, 4, v108
    v_mov_b32 v109, 0x3f80
    v_lshlrev_b32 v108, v108, v109
    v_lshrrev_b32 v109, 1, v106
    v_lshlrev_b32 v110, 1, v105
    v_cmp_eq_u32 vcc, v109, v110
    v_add_u32 v110, 1, v110
    s_nop 0
    v_cndmask_b32 v200, 0, v108, vcc
    v_cmp_eq_u32 vcc, v109, v110
    v_accvgpr_write_b32 a202, v200
    s_nop 0
    v_cndmask_b32 v201, 0, v108, vcc
    v_accvgpr_write_b32 a203, v201
    s_lshl_b32 s62, s28, 2
    v_add_u32 v108, s62, v105
    v_xor_b32 v109, v108, v106
    v_lshlrev_b32 v109, 4, v109
    v_lshl_or_b32 v109, v108, 8, v109
    v_add_u32 v168, 131072, v109
    s_sub_u32 s34, 131072, s31
    v_add_u32 v176, s34, v4
    v_add_u32 v177, s34, v5
    v_add_u32 v178, s34, v6
    v_add_u32 v179, s34, v7
    s_mov_b64 s[8:9], 0
    s_mov_b64 exec, 0
    s_cmp_eq_u32 s28, 1
    s_cbranch_scc1 L_hop1
    s_cmp_eq_u32 s28, 2
    s_cbranch_scc1 L_hop2
    s_cmp_eq_u32 s28, 3
    s_cbranch_scc1 L_hop3
L_back:
    s_mov_b64 exec, -1
    s_waitcnt vmcnt(10)
    v_lshlrev_b32 v200, 16, v136
    v_and_b32 v201, 0xffff0000, v136
    v_lshlrev_b32 v202, 16, v137
    v_and_b32 v203, 0xffff0000, v137
    v_lshlrev_b32 v204, 16, v138
    v_and_b32 v205, 0xffff0000, v138
    v_lshlrev_b32 v206, 16, v139
    v_and_b32 v207, 0xffff0000, v139
    v_pk_mul_f32 v[200:201], v[200:201], s[58:59]
    v_pk_mul_f32 v[202:203], v[202:203], s[58:59]
    v_pk_mul_f32 v[204:205], v[204:205], s[58:59]
    v_pk_mul_f32 v[206:207], v[206:207], s[58:59]
    v_cvt_pk_bf16_f32 v136, v200, v201
    v_cvt_pk_bf16_f32 v137, v202, v203
    v_cvt_pk_bf16_f32 v138, v204, v205
    v_cvt_pk_bf16_f32 v139, v206, v207
    ds_write_b128 v168, v[136:139] offset:0
    s_waitcnt vmcnt(9)
    v_lshlrev_b32 v208, 16, v140
    buffer_load_dwordx4 v18, s[16:19], s37 offen offset:2048 lds
    v_and_b32 v209, 0xffff0000, v140
    v_lshlrev_b32 v210, 16, v141
    v_and_b32 v211, 0xffff0000, v141
    v_lshlrev_b32 v212, 16, v142
    v_and_b32 v213, 0xffff0000, v142
    v_lshlrev_b32 v214, 16, v143
    v_and_b32 v215, 0xffff0000, v143
    v_pk_mul_f32 v[208:209], v[208:209], s[58:59]
    v_pk_mul_f32 v[210:211], v[210:211], s[58:59]
    v_pk_mul_f32 v[212:213], v[212:213], s[58:59]
    v_pk_mul_f32 v[214:215], v[214:215], s[58:59]
    v_cvt_pk_bf16_f32 v140, v208, v209
    v_cvt_pk_bf16_f32 v141, v210, v211
    v_cvt_pk_bf16_f32 v142, v212, v213
    v_cvt_pk_bf16_f32 v143, v214, v215
    ds_write_b128 v168, v[140:143] offset:4096
    s_waitcnt vmcnt(9)
    v_lshlrev_b32 v200, 16, v144
    buffer_load_dwordx4 v19, s[16:19], s37 offen offset:3072 lds
    s_add_u32 m0, s31, 8192
    v_and_b32 v201, 0xffff0000, v144
    v_lshlrev_b32 v202, 16, v145
    v_and_b32 v203, 0xffff0000, v145
    v_lshlrev_b32 v204, 16, v146
    v_and_b32 v205, 0xffff0000, v146
    v_lshlrev_b32 v206, 16, v147
    v_and_b32 v207, 0xffff0000, v147
    v_pk_mul_f32 v[200:201], v[200:201], s[58:59]
    v_pk_mul_f32 v[202:203], v[202:203], s[58:59]
    v_pk_mul_f32 v[204:205], v[204:205], s[58:59]
    v_pk_mul_f32 v[206:207], v[206:207], s[58:59]
    v_cvt_pk_bf16_f32 v144, v200, v201
    v_cvt_pk_bf16_f32 v145, v202, v203
    v_cvt_pk_bf16_f32 v146, v204, v205
    v_cvt_pk_bf16_f32 v147, v206, v207
    ds_write_b128 v168, v[144:147] offset:8192
    s_waitcnt lgkmcnt(0)
    s_barrier
    ds_read_b128 a[0:3], v176 offset:0
    ds_read_b128 a[4:7], v177 offset:0
    ds_read_b128 a[8:11], v178 offset:0
    ds_read_b128 a[12:15], v179 offset:0
    ds_read_b128 a[16:19], v176 offset:4096
    ds_read_b128 a[20:23], v177 offset:4096
    ds_read_b128 a[24:27], v178 offset:4096
    ds_read_b128 a[28:31], v179 offset:4096
    ds_read_b128 a[32:35], v176 offset:8192
    ds_read_b128 a[36:39], v177 offset:8192
    ds_read_b128 a[40:43], v178 offset:8192
    ds_read_b128 a[44:47], v179 offset:8192
    s_waitcnt vmcnt(6)
    ds_read_b128 a[80:83], v4 offset:0
    ds_read_b128 a[84:87], v5 offset:0
    ds_read_b128 a[88:91], v6 offset:0
    ds_read_b128 a[92:95], v7 offset:0
    buffer_load_dwordx4 v20, s[20:23], s36 offen lds
    buffer_load_dwordx4 v21, s[20:23], s36 offen offset:1024 lds
    buffer_load_dwordx4 v20, s[20:23], s36 offen offset:2048 lds
    buffer_load_dwordx4 v21, s[20:23], s36 offen offset:3072 lds
    s_add_u32 m0, s31, 12288
    s_waitcnt lgkmcnt(3)
    v_mfma_f32_16x16x32_bf16 v[96:99], a[80:83], a[0:3], 0
    s_waitcnt lgkmcnt(2)
    v_mfma_f32_16x16x32_bf16 v[96:99], a[84:87], a[4:7], v[96:99]
    s_waitcnt lgkmcnt(1)
    v_mfma_f32_16x16x32_bf16 v[96:99], a[88:91], a[8:11], v[96:99]
    s_waitcnt lgkmcnt(0)
    v_mfma_f32_16x16x32_bf16 v[96:99], a[92:95], a[12:15], v[96:99]
    v_mfma_f32_16x16x32_bf16 v[128:131], a[80:83], a[16:19], 0
    v_mfma_f32_16x16x32_bf16 v[128:131], a[84:87], a[20:23], v[128:131]
    v_mfma_f32_16x16x32_bf16 v[128:131], a[88:91], a[24:27], v[128:131]
    v_mfma_f32_16x16x32_bf16 v[128:131], a[92:95], a[28:31], v[128:131]
    v_mfma_f32_16x16x32_bf16 v[160:163], a[80:83], a[32:35], 0
    v_mfma_f32_16x16x32_bf16 v[160:163], a[84:87], a[36:39], v[160:163]
    v_mfma_f32_16x16x32_bf16 v[160:163], a[88:91], a[40:43], v[160:163]
    v_mfma_f32_16x16x32_bf16 v[160:163], a[92:95], a[44:47], v[160:163]
    v_max3_f32 v100, v96, v97, v98
    v_max_f32 v100, v100, v99
    ds_max_f32 v22, v100 offset:0
    s_waitcnt vmcnt(9)
    v_lshlrev_b32 v208, 16, v148
    buffer_load_dwordx4 v20, s[20:23], s37 offen lds
    v_and_b32 v209, 0xffff0000, v148
    v_lshlrev_b32 v210, 16, v149
    v_and_b32 v211, 0xffff0000, v149
    v_lshlrev_b32 v212, 16, v150
    v_and_b32 v213, 0xffff0000, v150
    v_lshlrev_b32 v214, 16, v151
    v_and_b32 v215, 0xffff0000, v151
    v_pk_mul_f32 v[208:209], v[208:209], s[58:59]
    v_pk_mul_f32 v[210:211], v[210:211], s[58:59]
    v_pk_mul_f32 v[212:213], v[212:213], s[58:59]
    v_pk_mul_f32 v[214:215], v[214:215], s[58:59]
    v_cvt_pk_bf16_f32 v148, v208, v209
    v_cvt_pk_bf16_f32 v149, v210, v211
    v_cvt_pk_bf16_f32 v150, v212, v213
    v_cvt_pk_bf16_f32 v151, v214, v215
    ds_write_b128 v168, v[148:151] offset:12288
    v_max3_f32 v132, v128, v129, v130
    v_max_f32 v132, v132, v131
    ds_max_f32 v22, v132 offset:64
    v_max3_f32 v164, v160, v161, v162
    v_max_f32 v164, v164, v163
    ds_max_f32 v22, v164 offset:128
    s_waitcnt vmcnt(9)
    v_lshlrev_b32 v200, 16, v152
    buffer_load_dwordx4 v21, s[20:23], s37 offen offset:1024 lds
    v_and_b32 v201, 0xffff0000, v152
    v_lshlrev_b32 v202, 16, v153
    v_and_b32 v203, 0xffff0000, v153
    v_lshlrev_b32 v204, 16, v154
    v_and_b32 v205, 0xffff0000, v154
    v_lshlrev_b32 v206, 16, v155
    v_and_b32 v207, 0xffff0000, v155
    v_pk_mul_f32 v[200:201], v[200:201], s[58:59]
    v_pk_mul_f32 v[202:203], v[202:203], s[58:59]
    v_pk_mul_f32 v[204:205], v[204:205], s[58:59]
    v_pk_mul_f32 v[206:207], v[206:207], s[58:59]
    v_cvt_pk_bf16_f32 v152, v200, v201
    v_cvt_pk_bf16_f32 v153, v202, v203
    v_cvt_pk_bf16_f32 v154, v204, v205
    v_cvt_pk_bf16_f32 v155, v206, v207
    ds_write_b128 v168, v[152:155] offset:16384
L_restart:
    s_waitcnt lgkmcnt(0)
    s_barrier
    ds_read_b128 a[48:51], v176 offset:12288
    ds_read_b128 a[52:55], v177 offset:12288
    ds_read_b128 a[56:59], v178 offset:12288
    ds_read_b128 a[60:63], v179 offset:12288
    ds_read_b128 a[64:67], v176 offset:16384
    ds_read_b128 a[68:71], v177 offset:16384
    ds_read_b128 a[72:75], v178 offset:16384
    ds_read_b128 a[76:79], v179 offset:16384
    ds_read_b32 v100, v22 offset:0
    ds_read_b32 v132, v22 offset:64
    ds_read_b32 v164, v22 offset:128
    s_waitcnt vmcnt(6)
    ds_read_b128 a[96:99], v4 offset:4096
    ds_read_b128 a[100:103], v5 offset:4096
    ds_read_b128 a[104:107], v6 offset:4096
    ds_read_b128 a[108:111], v7 offset:4096
    buffer_load_dwordx4 v20, s[20:23], s37 offen offset:2048 lds
    buffer_load_dwordx4 v21, s[20:23], s37 offen offset:3072 lds
    s_add_u32 m0, s31, 16384
    s_nop 0
    buffer_load_dwordx4 v16, s[16:19], s38 offen lds
    buffer_load_dwordx4 v17, s[16:19], s38 offen offset:1024 lds
    s_waitcnt lgkmcnt(6)
    v_sub_f32 v32, 0, v100
    v_sub_f32 v33, 0, v100
    v_sub_f32 v34, 0, v100
    v_sub_f32 v35, 0, v100
    v_mfma_f32_16x16x32_bf16 v[192:195], a[80:83], a[48:51], 0
    buffer_load_dwordx4 v18, s[16:19], s38 offen offset:2048 lds
    v_mfma_f32_16x16x32_bf16 v[192:195], a[84:87], a[52:55], v[192:195]
    v_sub_f32 v96, v96, v100
    v_sub_f32 v97, v97, v100
    v_mfma_f32_16x16x32_bf16 v[192:195], a[88:91], a[56:59], v[192:195]
    v_sub_f32 v98, v98, v100
    v_sub_f32 v99, v99, v100
    v_mfma_f32_16x16x32_bf16 v[192:195], a[92:95], a[60:63], v[192:195]
    s_waitcnt lgkmcnt(5)
    v_sub_f32 v36, 0, v132
    v_sub_f32 v37, 0, v132
    v_mfma_f32_16x16x32_bf16 v[224:227], a[80:83], a[64:67], 0
    buffer_load_dwordx4 v19, s[16:19], s38 offen offset:3072 lds
    v_mfma_f32_16x16x32_bf16 v[224:227], a[84:87], a[68:71], v[224:227]
    s_add_u32 m0, s31, 20480
    v_sub_f32 v38, 0, v132
    v_sub_f32 v39, 0, v132
    v_mfma_f32_16x16x32_bf16 v[224:227], a[88:91], a[72:75], v[224:227]
    v_max3_f32 v196, v192, v193, v194
    v_max_f32 v196, v196, v195
    v_mfma_f32_16x16x32_bf16 v[224:227], a[92:95], a[76:79], v[224:227]
    ds_max_f32 v22, v196 offset:192
    v_sub_f32 v128, v128, v132
    s_waitcnt lgkmcnt(4)
    v_mfma_f32_16x16x32_bf16 v[56:59], a[96:99], a[0:3], v[32:35]
    buffer_load_dwordx4 v16, s[16:19], s39 offen lds
    s_waitcnt lgkmcnt(3)
    v_mfma_f32_16x16x32_bf16 v[56:59], a[100:103], a[4:7], v[56:59]
    v_exp_f32 v96, v96
    s_waitcnt lgkmcnt(2)
    v_mfma_f32_16x16x32_bf16 v[56:59], a[104:107], a[8:11], v[56:59]
    v_max3_f32 v228, v224, v225, v226
    v_max_f32 v228, v228, v227
    s_waitcnt lgkmcnt(1)
    v_mfma_f32_16x16x32_bf16 v[56:59], a[108:111], a[12:15], v[56:59]
    ds_max_f32 v22, v228 offset:256
    v_sub_f32 v129, v129, v132
    v_mfma_f32_16x16x32_bf16 v[64:67], a[96:99], a[16:19], v[36:39]
    v_exp_f32 v97, v97
    v_mfma_f32_16x16x32_bf16 v[64:67], a[100:103], a[20:23], v[64:67]
    buffer_load_dwordx4 v17, s[16:19], s39 offen offset:1024 lds
    v_mfma_f32_16x16x32_bf16 v[64:67], a[104:107], a[24:27], v[64:67]
    v_exp_f32 v98, v98
    v_mfma_f32_16x16x32_bf16 v[64:67], a[108:111], a[28:31], v[64:67]
    v_sub_f32 v40, 0, v164
    v_sub_f32 v41, 0, v164
    v_sub_f32 v42, 0, v164
    v_sub_f32 v43, 0, v164
    s_waitcnt lgkmcnt(0)
    s_barrier
    ds_read_b32 v196, v22 offset:192
    ds_read_b32 v228, v22 offset:256
    v_exp_f32 v99, v99
    v_sub_f32 v130, v130, v132
    v_mfma_f32_16x16x32_bf16 v[72:75], a[96:99], a[32:35], v[40:43]
    buffer_load_dwordx4 v18, s[16:19], s39 offen offset:2048 lds
    v_sub_f32 v131, v131, v132
    v_mfma_f32_16x16x32_bf16 v[72:75], a[100:103], a[36:39], v[72:75]
    v_exp_f32 v56, v56
    v_cvt_pk_bf16_f32 v76, v96, v97
    v_mfma_f32_16x16x32_bf16 v[72:75], a[104:107], a[40:43], v[72:75]
    v_exp_f32 v57, v57
    v_exp_f32 v58, v58
    v_exp_f32 v59, v59
    s_waitcnt lgkmcnt(1)
    v_sub_f32 v44, 0, v196
    v_sub_f32 v45, 0, v196
    v_sub_f32 v46, 0, v196
    v_sub_f32 v47, 0, v196
    v_mfma_f32_16x16x32_bf16 v[72:75], a[108:111], a[44:47], v[72:75]
    s_waitcnt vmcnt(11)
    ds_read_b64_tr_b16 a[112:113], v8 offset:8192
    ds_read_b64_tr_b16 a[116:117], v9 offset:8192
    ds_read_b64_tr_b16 a[120:121], v10 offset:8192
    ds_read_b64_tr_b16 a[124:125], v11 offset:8192
    ds_read_b64_tr_b16 a[128:129], v12 offset:8192
    ds_read_b64_tr_b16 a[132:133], v13 offset:8192
    v_cvt_pk_bf16_f32 v77, v98, v99
    v_cvt_pk_bf16_f32 v78, v56, v57
    v_cvt_pk_bf16_f32 v79, v58, v59
    v_mfma_f32_16x16x32_bf16 v[56:59], a[96:99], a[48:51], v[44:47]
    ds_read_b64_tr_b16 a[136:137], v14 offset:8192
    ds_read_b64_tr_b16 a[140:141], v15 offset:8192
    s_waitcnt vmcnt(7)
    ds_read_b64_tr_b16 a[114:115], v8 offset:12288
    ds_read_b64_tr_b16 a[118:119], v9 offset:12288
    ds_read_b64_tr_b16 a[122:123], v10 offset:12288
    buffer_load_dwordx4 v19, s[16:19], s39 offen offset:3072 lds
    v_mfma_f32_16x16x32_bf16 v[56:59], a[100:103], a[52:55], v[56:59]
    s_add_u32 m0, s31, 24576
    ds_read_b64_tr_b16 a[126:127], v11 offset:12288
    ds_read_b64_tr_b16 a[130:131], v12 offset:12288
    ds_read_b64_tr_b16 a[134:135], v13 offset:12288
    ds_read_b64_tr_b16 a[138:139], v14 offset:12288
    ds_read_b64_tr_b16 a[142:143], v15 offset:12288
    v_mfma_f32_16x16x32_bf16 v[56:59], a[104:107], a[56:59], v[56:59]
    v_exp_f32 v128, v128
    v_sub_f32 v160, v160, v164
    v_mfma_f32_16x16x32_bf16 v[56:59], a[108:111], a[60:63], v[56:59]
    s_waitcnt lgkmcnt(0)
    v_exp_f32 v129, v129
    v_sub_f32 v161, v161, v164
    v_mfma_f32_16x16x32_bf16 a[176:179], a[196:199], v[76:79], 0
    buffer_load_dwordx4 v20, s[20:23], s38 offen lds
    v_sub_f32 v162, v162, v164
    v_mfma_f32_16x16x32_bf16 v[96:99], a[112:115], v[76:79], 0
    v_exp_f32 v130, v130
    v_sub_f32 v163, v163, v164
    v_mfma_f32_16x16x32_bf16 v[100:103], a[116:119], v[76:79], 0
    v_exp_f32 v131, v131
    v_cvt_pk_bf16_f32 v80, v128, v129
    v_mfma_f32_16x16x32_bf16 v[104:107], a[120:123], v[76:79], 0
    v_exp_f32 v64, v64
    v_cvt_pk_bf16_f32 v81, v130, v131
    v_mfma_f32_16x16x32_bf16 v[108:111], a[124:127], v[76:79], 0
    buffer_load_dwordx4 v21, s[20:23], s38 offen offset:1024 lds
    v_mfma_f32_16x16x32_bf16 v[112:115], a[128:131], v[76:79], 0
    v_exp_f32 v65, v65
    v_mfma_f32_16x16x32_bf16 v[116:119], a[132:135], v[76:79], 0
    v_exp_f32 v66, v66
    v_cvt_pk_bf16_f32 v82, v64, v65
    v_mfma_f32_16x16x32_bf16 v[120:123], a[136:139], v[76:79], 0
    v_exp_f32 v67, v67
    v_sub_f32 v48, 0, v228
    v_sub_f32 v49, 0, v228
    v_sub_f32 v50, 0, v228
    v_sub_f32 v51, 0, v228
    v_mfma_f32_16x16x32_bf16 v[124:127], a[140:143], v[76:79], 0
    buffer_load_dwordx4 v20, s[20:23], s38 offen offset:2048 lds
    v_cvt_pk_bf16_f32 v83, v66, v67
    v_mfma_f32_16x16x32_bf16 v[64:67], a[96:99], a[64:67], v[48:51]
    v_exp_f32 v160, v160
    v_sub_f32 v192, v192, v196
    v_mfma_f32_16x16x32_bf16 v[64:67], a[100:103], a[68:71], v[64:67]
    v_exp_f32 v161, v161
    v_sub_f32 v193, v193, v196
    v_mfma_f32_16x16x32_bf16 v[64:67], a[104:107], a[72:75], v[64:67]
    v_exp_f32 v162, v162
    v_cvt_pk_bf16_f32 v84, v160, v161
    v_mfma_f32_16x16x32_bf16 v[64:67], a[108:111], a[76:79], v[64:67]
    buffer_load_dwordx4 v21, s[20:23], s38 offen offset:3072 lds
    v_sub_f32 v194, v194, v196
    v_mfma_f32_16x16x32_bf16 a[180:183], a[196:199], v[80:83], 0
    s_add_u32 m0, s31, 28672
    v_exp_f32 v163, v163
    v_sub_f32 v195, v195, v196
    v_mfma_f32_16x16x32_bf16 v[128:131], a[112:115], v[80:83], 0
    v_exp_f32 v72, v72
    v_cvt_pk_bf16_f32 v85, v162, v163
    v_mfma_f32_16x16x32_bf16 v[132:135], a[116:119], v[80:83], 0
    v_exp_f32 v73, v73
    v_mfma_f32_16x16x32_bf16 v[136:139], a[120:123], v[80:83], 0
    buffer_load_dwordx4 v20, s[20:23], s39 offen lds
    v_cvt_pk_bf16_f32 v86, v72, v73
    v_mfma_f32_16x16x32_bf16 v[140:143], a[124:127], v[80:83], 0
    v_exp_f32 v74, v74
    v_mfma_f32_16x16x32_bf16 v[144:147], a[128:131], v[80:83], 0
    v_exp_f32 v75, v75
    v_mfma_f32_16x16x32_bf16 v[148:151], a[132:135], v[80:83], 0
    v_exp_f32 v192, v192
    v_cvt_pk_bf16_f32 v87, v74, v75
    v_mfma_f32_16x16x32_bf16 v[152:155], a[136:139], v[80:83], 0
    buffer_load_dwordx4 v21, s[20:23], s39 offen offset:1024 lds
    v_mfma_f32_16x16x32_bf16 v[156:159], a[140:143], v[80:83], 0
    v_exp_f32 v193, v193
    v_mfma_f32_16x16x32_bf16 a[184:187], a[196:199], v[84:87], 0
    v_exp_f32 v194, v194
    v_cvt_pk_bf16_f32 v88, v192, v193
    v_mfma_f32_16x16x32_bf16 v[160:163], a[112:115], v[84:87], 0
    s_waitcnt vmcnt(10)
    ds_read_b128 a[208:211], v4 offset:16384
    ds_read_b128 a[212:215], v5 offset:16384
    v_mfma_f32_16x16x32_bf16 v[164:167], a[116:119], v[84:87], 0
    ds_read_b128 a[216:219], v6 offset:16384
    ds_read_b128 a[220:223], v7 offset:16384
    buffer_load_dwordx4 v20, s[20:23], s39 offen offset:2048 lds
    v_mfma_f32_16x16x32_bf16 v[168:171], a[120:123], v[84:87], 0
    s_waitcnt vmcnt(7)
    ds_read_b128 a[224:227], v4 offset:20480
    v_sub_f32 v224, v224, v228
    v_mfma_f32_16x16x32_bf16 v[172:175], a[124:127], v[84:87], 0
    ds_read_b128 a[228:231], v5 offset:20480
    ds_read_b128 a[232:235], v6 offset:20480
    v_mfma_f32_16x16x32_bf16 v[176:179], a[128:131], v[84:87], 0
    ds_read_b128 a[236:239], v7 offset:20480
    v_sub_f32 v225, v225, v228
    v_mfma_f32_16x16x32_bf16 v[180:183], a[132:135], v[84:87], 0
    buffer_load_dwordx4 v21, s[20:23], s39 offen offset:3072 lds
    v_mfma_f32_16x16x32_bf16 v[184:187], a[136:139], v[84:87], 0
    s_mov_b32 m0, s31
    v_exp_f32 v195, v195
    v_mfma_f32_16x16x32_bf16 v[188:191], a[140:143], v[84:87], 0
    s_waitcnt lgkmcnt(0)
    v_exp_f32 v56, v56
    v_cvt_pk_bf16_f32 v89, v194, v195
    v_mfma_f32_16x16x32_bf16 v[68:71], a[208:211], a[0:3], v[32:35]
    v_exp_f32 v57, v57
    v_sub_f32 v226, v226, v228
    v_mfma_f32_16x16x32_bf16 v[68:71], a[212:215], a[4:7], v[68:71]
    buffer_load_dwordx4 v16, s[16:19], s40 offen lds
    v_cvt_pk_bf16_f32 v90, v56, v57
    v_mfma_f32_16x16x32_bf16 v[68:71], a[216:219], a[8:11], v[68:71]
    v_exp_f32 v58, v58
    v_sub_f32 v227, v227, v228
    v_mfma_f32_16x16x32_bf16 v[68:71], a[220:223], a[12:15], v[68:71]
    v_exp_f32 v59, v59
    v_mfma_f32_16x16x32_bf16 v[72:75], a[224:227], a[0:3], v[32:35]
    s_waitcnt vmcnt(5)
    ds_read_b64_tr_b16 a[144:145], v8 offset:24576
    v_cvt_pk_bf16_f32 v91, v58, v59
    v_mfma_f32_16x16x32_bf16 v[72:75], a[228:231], a[4:7], v[72:75]
    buffer_load_dwordx4 v17, s[16:19], s40 offen offset:1024 lds
    v_mfma_f32_16x16x32_bf16 v[72:75], a[232:235], a[8:11], v[72:75]
    v_exp_f32 v224, v224
    v_mfma_f32_16x16x32_bf16 v[72:75], a[236:239], a[12:15], v[72:75]
    ds_read_b64_tr_b16 a[148:149], v9 offset:24576
    v_exp_f32 v225, v225
    v_mfma_f32_16x16x32_bf16 a[188:191], a[196:199], v[88:91], 0
    v_exp_f32 v226, v226
    v_cvt_pk_bf16_f32 v92, v224, v225
    v_mfma_f32_16x16x32_bf16 v[192:195], a[112:115], v[88:91], 0
    buffer_load_dwordx4 v18, s[16:19], s40 offen offset:2048 lds
    v_mfma_f32_16x16x32_bf16 v[196:199], a[116:119], v[88:91], 0
    ds_read_b64_tr_b16 a[152:153], v10 offset:24576
    v_exp_f32 v227, v227
    v_mfma_f32_16x16x32_bf16 v[200:203], a[120:123], v[88:91], 0
    ds_read_b64_tr_b16 a[156:157], v11 offset:24576
    v_cvt_pk_bf16_f32 v93, v226, v227
    v_mfma_f32_16x16x32_bf16 v[204:207], a[124:127], v[88:91], 0
L_hop1:
    s_cbranch_execz L_back
    v_exp_f32 v64, v64
    v_mfma_f32_16x16x32_bf16 v[208:211], a[128:131], v[88:91], 0
    buffer_load_dwordx4 v19, s[16:19], s40 offen offset:3072 lds
    v_mfma_f32_16x16x32_bf16 v[212:215], a[132:135], v[88:91], 0
    s_add_u32 m0, s31, 4096
    ds_read_b64_tr_b16 a[160:161], v12 offset:24576
    v_exp_f32 v65, v65
    v_mfma_f32_16x16x32_bf16 v[216:219], a[136:139], v[88:91], 0
    ds_read_b64_tr_b16 a[164:165], v13 offset:24576
    v_cvt_pk_bf16_f32 v94, v64, v65
    v_mfma_f32_16x16x32_bf16 v[220:223], a[140:143], v[88:91], 0
    v_exp_f32 v66, v66
    v_mfma_f32_16x16x32_bf16 v[52:55], a[208:211], a[16:19], v[36:39]
    buffer_load_dwordx4 v16, s[16:19], s41 offen lds
    v_mfma_f32_16x16x32_bf16 v[52:55], a[212:215], a[20:23], v[52:55]
    ds_read_b64_tr_b16 a[168:169], v14 offset:24576
    v_exp_f32 v67, v67
    v_mfma_f32_16x16x32_bf16 v[52:55], a[216:219], a[24:27], v[52:55]
    ds_read_b64_tr_b16 a[172:173], v15 offset:24576
    v_cvt_pk_bf16_f32 v95, v66, v67
    v_mfma_f32_16x16x32_bf16 v[52:55], a[220:223], a[28:31], v[52:55]
    v_exp_f32 v68, v68
    v_mfma_f32_16x16x32_bf16 v[56:59], a[224:227], a[16:19], v[36:39]
    v_exp_f32 v69, v69
    v_mfma_f32_16x16x32_bf16 v[56:59], a[228:231], a[20:23], v[56:59]
    s_waitcnt vmcnt(5)
    ds_read_b64_tr_b16 a[146:147], v8 offset:28672
    v_cvt_pk_bf16_f32 v76, v68, v69
    v_mfma_f32_16x16x32_bf16 v[56:59], a[232:235], a[24:27], v[56:59]
    v_exp_f32 v70, v70
    v_mfma_f32_16x16x32_bf16 v[56:59], a[236:239], a[28:31], v[56:59]
    ds_read_b64_tr_b16 a[150:151], v9 offset:28672
    v_exp_f32 v71, v71
    v_mfma_f32_16x16x32_bf16 a[192:195], a[196:199], v[92:95], 0
    buffer_load_dwordx4 v17, s[16:19], s41 offen offset:1024 lds
    v_mfma_f32_16x16x32_bf16 v[224:227], a[112:115], v[92:95], 0
    ds_read_b64_tr_b16 a[154:155], v10 offset:28672
    v_cvt_pk_bf16_f32 v77, v70, v71
    v_mfma_f32_16x16x32_bf16 v[228:231], a[116:119], v[92:95], 0
    v_exp_f32 v72, v72
    v_mfma_f32_16x16x32_bf16 v[232:235], a[120:123], v[92:95], 0
    ds_read_b64_tr_b16 a[158:159], v11 offset:28672
    v_exp_f32 v73, v73
    v_mfma_f32_16x16x32_bf16 v[236:239], a[124:127], v[92:95], 0
    buffer_load_dwordx4 v18, s[16:19], s41 offen offset:2048 lds
    v_mfma_f32_16x16x32_bf16 v[240:243], a[128:131], v[92:95], 0
    ds_read_b64_tr_b16 a[162:163], v12 offset:28672
    v_cvt_pk_bf16_f32 v78, v72, v73
    v_mfma_f32_16x16x32_bf16 v[244:247], a[132:135], v[92:95], 0
    v_exp_f32 v74, v74
    v_mfma_f32_16x16x32_bf16 v[248:251], a[136:139], v[92:95], 0
    v_exp_f32 v75, v75
    v_mfma_f32_16x16x32_bf16 v[252:255], a[140:143], v[92:95], 0
    ds_read_b64_tr_b16 a[166:167], v13 offset:28672
    v_cvt_pk_bf16_f32 v79, v74, v75
    v_mfma_f32_16x16x32_bf16 v[60:63], a[208:211], a[32:35], v[40:43]
    buffer_load_dwordx4 v19, s[16:19], s41 offen offset:3072 lds
    v_mfma_f32_16x16x32_bf16 v[60:63], a[212:215], a[36:39], v[60:63]
    s_add_u32 m0, s31, 8192
    ds_read_b64_tr_b16 a[170:171], v14 offset:28672
    v_exp_f32 v52, v52
    v_mfma_f32_16x16x32_bf16 v[60:63], a[216:219], a[40:43], v[60:63]
    ds_read_b64_tr_b16 a[174:175], v15 offset:28672
    v_mfma_f32_16x16x32_bf16 v[60:63], a[220:223], a[44:47], v[60:63]
    buffer_load_dwordx4 v20, s[20:23], s40 offen lds
    v_mfma_f32_16x16x32_bf16 v[64:67], a[224:227], a[32:35], v[40:43]
    v_exp_f32 v53, v53
    v_mfma_f32_16x16x32_bf16 v[64:67], a[228:231], a[36:39], v[64:67]
    v_exp_f32 v54, v54
    v_mfma_f32_16x16x32_bf16 v[64:67], a[232:235], a[40:43], v[64:67]
    v_exp_f32 v55, v55
    v_mfma_f32_16x16x32_bf16 v[64:67], a[236:239], a[44:47], v[64:67]
    s_waitcnt lgkmcnt(0)
    v_cvt_pk_bf16_f32 v80, v52, v53
    v_cvt_pk_bf16_f32 v81, v54, v55
    v_mfma_f32_16x16x32_bf16 a[176:179], a[196:199], v[76:79], a[176:179]
    buffer_load_dwordx4 v21, s[20:23], s40 offen offset:1024 lds
    v_mfma_f32_16x16x32_bf16 v[96:99], a[144:147], v[76:79], v[96:99]
    v_exp_f32 v56, v56
    v_mfma_f32_16x16x32_bf16 v[100:103], a[148:151], v[76:79], v[100:103]
    v_exp_f32 v57, v57
    v_mfma_f32_16x16x32_bf16 v[104:107], a[152:155], v[76:79], v[104:107]
    buffer_load_dwordx4 v20, s[20:23], s40 offen offset:2048 lds
    v_mfma_f32_16x16x32_bf16 v[108:111], a[156:159], v[76:79], v[108:111]
    v_exp_f32 v58, v58
    v_mfma_f32_16x16x32_bf16 v[112:115], a[160:163], v[76:79], v[112:115]
    v_exp_f32 v59, v59
    v_mfma_f32_16x16x32_bf16 v[116:119], a[164:167], v[76:79], v[116:119]
    v_cvt_pk_bf16_f32 v82, v56, v57
    v_cvt_pk_bf16_f32 v83, v58, v59
    v_mfma_f32_16x16x32_bf16 v[120:123], a[168:171], v[76:79], v[120:123]
    buffer_load_dwordx4 v21, s[20:23], s40 offen offset:3072 lds
    v_mfma_f32_16x16x32_bf16 v[124:127], a[172:175], v[76:79], v[124:127]
    s_add_u32 m0, s31, 12288
    v_exp_f32 v60, v60
    v_mfma_f32_16x16x32_bf16 v[68:71], a[208:211], a[48:51], v[44:47]
    v_exp_f32 v61, v61
    v_mfma_f32_16x16x32_bf16 v[68:71], a[212:215], a[52:55], v[68:71]
    buffer_load_dwordx4 v20, s[20:23], s41 offen lds
    v_mfma_f32_16x16x32_bf16 v[68:71], a[216:219], a[56:59], v[68:71]
    v_exp_f32 v62, v62
    v_mfma_f32_16x16x32_bf16 v[68:71], a[220:223], a[60:63], v[68:71]
    v_exp_f32 v63, v63
    v_mfma_f32_16x16x32_bf16 v[72:75], a[224:227], a[48:51], v[44:47]
    s_waitcnt vmcnt(9)
    ds_read_b128 a[80:83], v4 offset:0
    v_cvt_pk_bf16_f32 v84, v60, v61
    v_mfma_f32_16x16x32_bf16 v[72:75], a[228:231], a[52:55], v[72:75]
    buffer_load_dwordx4 v21, s[20:23], s41 offen offset:1024 lds
    v_mfma_f32_16x16x32_bf16 v[72:75], a[232:235], a[56:59], v[72:75]
    v_exp_f32 v64, v64
    v_mfma_f32_16x16x32_bf16 v[72:75], a[236:239], a[60:63], v[72:75]
    ds_read_b128 a[84:87], v5 offset:0
    v_cvt_pk_bf16_f32 v85, v62, v63
    v_mfma_f32_16x16x32_bf16 a[180:183], a[196:199], v[80:83], a[180:183]
    v_exp_f32 v65, v65
    v_mfma_f32_16x16x32_bf16 v[128:131], a[144:147], v[80:83], v[128:131]
    v_exp_f32 v66, v66
    v_mfma_f32_16x16x32_bf16 v[132:135], a[148:151], v[80:83], v[132:135]
    buffer_load_dwordx4 v20, s[20:23], s41 offen offset:2048 lds
    v_mfma_f32_16x16x32_bf16 v[136:139], a[152:155], v[80:83], v[136:139]
    ds_read_b128 a[88:91], v6 offset:0
    v_cvt_pk_bf16_f32 v86, v64, v65
    v_mfma_f32_16x16x32_bf16 v[140:143], a[156:159], v[80:83], v[140:143]
    v_exp_f32 v67, v67
    v_mfma_f32_16x16x32_bf16 v[144:147], a[160:163], v[80:83], v[144:147]
    ds_read_b128 a[92:95], v7 offset:0
    v_cvt_pk_bf16_f32 v87, v66, v67
    v_mfma_f32_16x16x32_bf16 v[148:151], a[164:167], v[80:83], v[148:151]
    v_exp_f32 v68, v68
    v_mfma_f32_16x16x32_bf16 v[152:155], a[168:171], v[80:83], v[152:155]
    buffer_load_dwordx4 v21, s[20:23], s41 offen offset:3072 lds
    v_mfma_f32_16x16x32_bf16 v[156:159], a[172:175], v[80:83], v[156:159]
    s_add_u32 m0, s31, 16384
    v_exp_f32 v69, v69
    v_mfma_f32_16x16x32_bf16 v[52:55], a[208:211], a[64:67], v[48:51]
    s_waitcnt vmcnt(8)
    ds_read_b128 a[96:99], v4 offset:4096
    v_cvt_pk_bf16_f32 v88, v68, v69
    v_mfma_f32_16x16x32_bf16 v[52:55], a[212:215], a[68:71], v[52:55]
    v_exp_f32 v70, v70
    v_mfma_f32_16x16x32_bf16 v[52:55], a[216:219], a[72:75], v[52:55]
    buffer_load_dwordx4 v16, s[16:19], s42 offen lds
    v_mfma_f32_16x16x32_bf16 v[52:55], a[220:223], a[76:79], v[52:55]
    v_exp_f32 v71, v71
    v_mfma_f32_16x16x32_bf16 v[56:59], a[224:227], a[64:67], v[48:51]
    ds_read_b128 a[100:103], v5 offset:4096
    v_cvt_pk_bf16_f32 v89, v70, v71
    v_mfma_f32_16x16x32_bf16 v[56:59], a[228:231], a[68:71], v[56:59]
    v_exp_f32 v72, v72
    v_mfma_f32_16x16x32_bf16 v[56:59], a[232:235], a[72:75], v[56:59]
    v_exp_f32 v73, v73
    v_mfma_f32_16x16x32_bf16 v[56:59], a[236:239], a[76:79], v[56:59]
    ds_read_b128 a[104:107], v6 offset:4096
    v_cvt_pk_bf16_f32 v90, v72, v73
    v_mfma_f32_16x16x32_bf16 a[184:187], a[196:199], v[84:87], a[184:187]
    buffer_load_dwordx4 v17, s[16:19], s42 offen offset:1024 lds
    v_mfma_f32_16x16x32_bf16 v[160:163], a[144:147], v[84:87], v[160:163]
    v_exp_f32 v74, v74
    v_mfma_f32_16x16x32_bf16 v[164:167], a[148:151], v[84:87], v[164:167]
    v_exp_f32 v75, v75
    v_mfma_f32_16x16x32_bf16 v[168:171], a[152:155], v[84:87], v[168:171]
    ds_read_b128 a[108:111], v7 offset:4096
    v_cvt_pk_bf16_f32 v91, v74, v75
    v_mfma_f32_16x16x32_bf16 v[172:175], a[156:159], v[84:87], v[172:175]
    buffer_load_dwordx4 v18, s[16:19], s42 offen offset:2048 lds
    v_mfma_f32_16x16x32_bf16 v[176:179], a[160:163], v[84:87], v[176:179]
    v_exp_f32 v52, v52
    v_mfma_f32_16x16x32_bf16 v[180:183], a[164:167], v[84:87], v[180:183]
    v_exp_f32 v53, v53
    v_mfma_f32_16x16x32_bf16 v[184:187], a[168:171], v[84:87], v[184:187]
    s_waitcnt vmcnt(7)
    ds_read_b64_tr_b16 a[112:113], v8 offset:8192
    v_cvt_pk_bf16_f32 v92, v52, v53
    v_mfma_f32_16x16x32_bf16 v[188:191], a[172:175], v[84:87], v[188:191]
    s_waitcnt lgkmcnt(1)
    buffer_load_dwordx4 v19, s[16:19], s42 offen offset:3072 lds
    v_mfma_f32_16x16x32_bf16 v[60:63], a[80:83], a[0:3], v[32:35]
    s_add_u32 m0, s31, 20480
    v_exp_f32 v54, v54
    v_mfma_f32_16x16x32_bf16 v[60:63], a[84:87], a[4:7], v[60:63]
    v_exp_f32 v55, v55
    v_mfma_f32_16x16x32_bf16 v[60:63], a[88:91], a[8:11], v[60:63]
    ds_read_b64_tr_b16 a[116:117], v9 offset:8192
    v_cvt_pk_bf16_f32 v93, v54, v55
    v_mfma_f32_16x16x32_bf16 v[60:63], a[92:95], a[12:15], v[60:63]
    buffer_load_dwordx4 v16, s[16:19], s43 offen lds
    v_mfma_f32_16x16x32_bf16 v[64:67], a[96:99], a[0:3], v[32:35]
    v_exp_f32 v56, v56
    v_mfma_f32_16x16x32_bf16 v[64:67], a[100:103], a[4:7], v[64:67]
    v_exp_f32 v57, v57
    v_mfma_f32_16x16x32_bf16 v[64:67], a[104:107], a[8:11], v[64:67]
    ds_read_b64_tr_b16 a[120:121], v10 offset:8192
    v_cvt_pk_bf16_f32 v94, v56, v57
    v_mfma_f32_16x16x32_bf16 v[64:67], a[108:111], a[12:15], v[64:67]
    v_exp_f32 v58, v58
    v_mfma_f32_16x16x32_bf16 a[188:191], a[196:199], v[88:91], a[188:191]
    ds_read_b64_tr_b16 a[124:125], v11 offset:8192
    v_mfma_f32_16x16x32_bf16 v[192:195], a[144:147], v[88:91], v[192:195]
    buffer_load_dwordx4 v17, s[16:19], s43 offen offset:1024 lds
    v_mfma_f32_16x16x32_bf16 v[196:199], a[148:151], v[88:91], v[196:199]
    v_exp_f32 v59, v59
    v_mfma_f32_16x16x32_bf16 v[200:203], a[152:155], v[88:91], v[200:203]
    ds_read_b64_tr_b16 a[128:129], v12 offset:8192
    v_cvt_pk_bf16_f32 v95, v58, v59
    v_mfma_f32_16x16x32_bf16 v[204:207], a[156:159], v[88:91], v[204:207]
    v_exp_f32 v60, v60
    v_mfma_f32_16x16x32_bf16 v[208:211], a[160:163], v[88:91], v[208:211]
    ds_read_b64_tr_b16 a[132:133], v13 offset:8192
    v_mfma_f32_16x16x32_bf16 v[212:215], a[164:167], v[88:91], v[212:215]
    buffer_load_dwordx4 v18, s[16:19], s43 offen offset:2048 lds
    v_mfma_f32_16x16x32_bf16 v[216:219], a[168:171], v[88:91], v[216:219]
    v_exp_f32 v61, v61
    v_mfma_f32_16x16x32_bf16 v[220:223], a[172:175], v[88:91], v[220:223]
    ds_read_b64_tr_b16 a[136:137], v14 offset:8192
    v_cvt_pk_bf16_f32 v76, v60, v61
    v_mfma_f32_16x16x32_bf16 v[68:71], a[80:83], a[16:19], v[36:39]
    buffer_load_dwordx4 v19, s[16:19], s43 offen offset:3072 lds
    v_mfma_f32_16x16x32_bf16 v[68:71], a[84:87], a[20:23], v[68:71]
    s_add_u32 m0, s31, 24576
    ds_read_b64_tr_b16 a[140:141], v15 offset:8192
    v_mfma_f32_16x16x32_bf16 v[68:71], a[88:91], a[24:27], v[68:71]
    v_exp_f32 v62, v62
    v_mfma_f32_16x16x32_bf16 v[68:71], a[92:95], a[28:31], v[68:71]
    v_exp_f32 v63, v63
    v_mfma_f32_16x16x32_bf16 v[72:75], a[96:99], a[16:19], v[36:39]
    s_waitcnt vmcnt(8)
    ds_read_b64_tr_b16 a[114:115], v8 offset:12288
    v_cvt_pk_bf16_f32 v77, v62, v63
    v_mfma_f32_16x16x32_bf16 v[72:75], a[100:103], a[20:23], v[72:75]
    buffer_load_dwordx4 v20, s[20:23], s42 offen lds
    v_mfma_f32_16x16x32_bf16 v[72:75], a[104:107], a[24:27], v[72:75]
    ds_read_b64_tr_b16 a[118:119], v9 offset:12288
    v_mfma_f32_16x16x32_bf16 v[72:75], a[108:111], a[28:31], v[72:75]
    v_exp_f32 v64, v64
    v_mfma_f32_16x16x32_bf16 a[192:195], a[196:199], v[92:95], a[192:195]
    v_exp_f32 v65, v65
    v_mfma_f32_16x16x32_bf16 v[224:227], a[144:147], v[92:95], v[224:227]
    ds_read_b64_tr_b16 a[122:123], v10 offset:12288
    v_cvt_pk_bf16_f32 v78, v64, v65
    v_mfma_f32_16x16x32_bf16 v[228:231], a[148:151], v[92:95], v[228:231]
    buffer_load_dwordx4 v21, s[20:23], s42 offen offset:1024 lds
    v_mfma_f32_16x16x32_bf16 v[232:235], a[152:155], v[92:95], v[232:235]
    ds_read_b64_tr_b16 a[126:127], v11 offset:12288
    v_mfma_f32_16x16x32_bf16 v[236:239], a[156:159], v[92:95], v[236:239]
    v_exp_f32 v66, v66
    v_mfma_f32_16x16x32_bf16 v[240:243], a[160:163], v[92:95], v[240:243]
    v_exp_f32 v67, v67
    v_mfma_f32_16x16x32_bf16 v[244:247], a[164:167], v[92:95], v[244:247]
    ds_read_b64_tr_b16 a[130:131], v12 offset:12288
    v_cvt_pk_bf16_f32 v79, v66, v67
    v_mfma_f32_16x16x32_bf16 v[248:251], a[168:171], v[92:95], v[248:251]
    v_exp_f32 v68, v68
    v_mfma_f32_16x16x32_bf16 v[252:255], a[172:175], v[92:95], v[252:255]
    ds_read_b64_tr_b16 a[134:135], v13 offset:12288
    v_mfma_f32_16x16x32_bf16 v[52:55], a[80:83], a[32:35], v[40:43]
    buffer_load_dwordx4 v20, s[20:23], s42 offen offset:2048 lds
    v_mfma_f32_16x16x32_bf16 v[52:55], a[84:87], a[36:39], v[52:55]
    ds_read_b64_tr_b16 a[138:139], v14 offset:12288
    v_mfma_f32_16x16x32_bf16 v[52:55], a[88:91], a[40:43], v[52:55]
    ds_read_b64_tr_b16 a[142:143], v15 offset:12288
    v_mfma_f32_16x16x32_bf16 v[52:55], a[92:95], a[44:47], v[52:55]
    v_exp_f32 v69, v69
    v_mfma_f32_16x16x32_bf16 v[56:59], a[96:99], a[32:35], v[40:43]
    v_exp_f32 v70, v70
    v_mfma_f32_16x16x32_bf16 v[56:59], a[100:103], a[36:39], v[56:59]
    buffer_load_dwordx4 v21, s[20:23], s42 offen offset:3072 lds
    v_mfma_f32_16x16x32_bf16 v[56:59], a[104:107], a[40:43], v[56:59]
    s_add_u32 m0, s31, 28672
    v_exp_f32 v71, v71
    v_mfma_f32_16x16x32_bf16 v[56:59], a[108:111], a[44:47], v[56:59]
    s_waitcnt lgkmcnt(0)
    v_cvt_pk_bf16_f32 v80, v68, v69
    v_cvt_pk_bf16_f32 v81, v70, v71
    v_mfma_f32_16x16x32_bf16 a[176:179], a[196:199], v[76:79], a[176:179]
    v_exp_f32 v72, v72
    v_mfma_f32_16x16x32_bf16 v[96:99], a[112:115], v[76:79], v[96:99]
    buffer_load_dwordx4 v20, s[20:23], s43 offen lds
    v_mfma_f32_16x16x32_bf16 v[100:103], a[116:119], v[76:79], v[100:103]
    v_exp_f32 v73, v73
    v_mfma_f32_16x16x32_bf16 v[104:107], a[120:123], v[76:79], v[104:107]
    v_exp_f32 v74, v74
    v_mfma_f32_16x16x32_bf16 v[108:111], a[124:127], v[76:79], v[108:111]
    buffer_load_dwordx4 v21, s[20:23], s43 offen offset:1024 lds
    v_mfma_f32_16x16x32_bf16 v[112:115], a[128:131], v[76:79], v[112:115]
    v_exp_f32 v75, v75
    v_mfma_f32_16x16x32_bf16 v[116:119], a[132:135], v[76:79], v[116:119]
    v_cvt_pk_bf16_f32 v82, v72, v73
    v_cvt_pk_bf16_f32 v83, v74, v75
    v_mfma_f32_16x16x32_bf16 v[120:123], a[136:139], v[76:79], v[120:123]
    v_exp_f32 v52, v52
    v_mfma_f32_16x16x32_bf16 v[124:127], a[140:143], v[76:79], v[124:127]
    buffer_load_dwordx4 v20, s[20:23], s43 offen offset:2048 lds
    v_mfma_f32_16x16x32_bf16 v[60:63], a[80:83], a[48:51], v[44:47]
    v_exp_f32 v53, v53
    v_mfma_f32_16x16x32_bf16 v[60:63], a[84:87], a[52:55], v[60:63]
    v_exp_f32 v54, v54
    v_mfma_f32_16x16x32_bf16 v[60:63], a[88:91], a[56:59], v[60:63]
    v_exp_f32 v55, v55
    v_mfma_f32_16x16x32_bf16 v[60:63], a[92:95], a[60:63], v[60:63]
    v_cvt_pk_bf16_f32 v84, v52, v53
    v_cvt_pk_bf16_f32 v85, v54, v55
    v_mfma_f32_16x16x32_bf16 v[64:67], a[96:99], a[48:51], v[44:47]
    buffer_load_dwordx4 v21, s[20:23], s43 offen offset:3072 lds
    v_mfma_f32_16x16x32_bf16 v[64:67], a[100:103], a[52:55], v[64:67]
    s_mov_b32 m0, s31
    v_exp_f32 v56, v56
    v_mfma_f32_16x16x32_bf16 v[64:67], a[104:107], a[56:59], v[64:67]
    v_exp_f32 v57, v57
    v_mfma_f32_16x16x32_bf16 v[64:67], a[108:111], a[60:63], v[64:67]
    s_waitcnt vmcnt(12)
    ds_read_b128 a[208:211], v4 offset:16384
    v_cvt_pk_bf16_f32 v86, v56, v57
    v_mfma_f32_16x16x32_bf16 a[180:183], a[196:199], v[80:83], a[180:183]
    buffer_load_dwordx4 v16, s[16:19], s44 offen lds
    v_mfma_f32_16x16x32_bf16 v[128:131], a[112:115], v[80:83], v[128:131]
    v_exp_f32 v58, v58
    v_mfma_f32_16x16x32_bf16 v[132:135], a[116:119], v[80:83], v[132:135]
    v_exp_f32 v59, v59
    v_mfma_f32_16x16x32_bf16 v[136:139], a[120:123], v[80:83], v[136:139]
    ds_read_b128 a[212:215], v5 offset:16384
    v_cvt_pk_bf16_f32 v87, v58, v59
    v_mfma_f32_16x16x32_bf16 v[140:143], a[124:127], v[80:83], v[140:143]
    buffer_load_dwordx4 v17, s[16:19], s44 offen offset:1024 lds
    v_mfma_f32_16x16x32_bf16 v[144:147], a[128:131], v[80:83], v[144:147]
    v_exp_f32 v60, v60
    v_mfma_f32_16x16x32_bf16 v[148:151], a[132:135], v[80:83], v[148:151]
    v_exp_f32 v61, v61
    v_mfma_f32_16x16x32_bf16 v[152:155], a[136:139], v[80:83], v[152:155]
    ds_read_b128 a[216:219], v6 offset:16384
    v_cvt_pk_bf16_f32 v88, v60, v61
    v_mfma_f32_16x16x32_bf16 v[156:159], a[140:143], v[80:83], v[156:159]
    v_exp_f32 v62, v62
    v_mfma_f32_16x16x32_bf16 v[68:71], a[80:83], a[64:67], v[48:51]
    buffer_load_dwordx4 v18, s[16:19], s44 offen offset:2048 lds
    v_mfma_f32_16x16x32_bf16 v[68:71], a[84:87], a[68:71], v[68:71]
    ds_read_b128 a[220:223], v7 offset:16384
    v_mfma_f32_16x16x32_bf16 v[68:71], a[88:91], a[72:75], v[68:71]
    v_exp_f32 v63, v63
    v_mfma_f32_16x16x32_bf16 v[68:71], a[92:95], a[76:79], v[68:71]
    s_waitcnt vmcnt(11)
    ds_read_b128 a[224:227], v4 offset:20480
    v_cvt_pk_bf16_f32 v89, v62, v63
    v_mfma_f32_16x16x32_bf16 v[72:75], a[96:99], a[64:67], v[48:51]
    buffer_load_dwordx4 v19, s[16:19], s44 offen offset:3072 lds
    v_mfma_f32_16x16x32_bf16 v[72:75], a[100:103], a[68:71], v[72:75]
    s_add_u32 m0, s31, 4096
    v_exp_f32 v64, v64
    v_mfma_f32_16x16x32_bf16 v[72:75], a[104:107], a[72:75], v[72:75]
    v_exp_f32 v65, v65
    v_mfma_f32_16x16x32_bf16 v[72:75], a[108:111], a[76:79], v[72:75]
    ds_read_b128 a[228:231], v5 offset:20480
    v_cvt_pk_bf16_f32 v90, v64, v65
    v_mfma_f32_16x16x32_bf16 a[184:187], a[196:199], v[84:87], a[184:187]
    v_exp_f32 v66, v66
    v_mfma_f32_16x16x32_bf16 v[160:163], a[112:115], v[84:87], v[160:163]
    buffer_load_dwordx4 v16, s[16:19], s45 offen lds
    v_mfma_f32_16x16x32_bf16 v[164:167], a[116:119], v[84:87], v[164:167]
    ds_read_b128 a[232:235], v6 offset:20480
    v_mfma_f32_16x16x32_bf16 v[168:171], a[120:123], v[84:87], v[168:171]
    ds_read_b128 a[236:239], v7 offset:20480
    v_mfma_f32_16x16x32_bf16 v[172:175], a[124:127], v[84:87], v[172:175]
    v_exp_f32 v67, v67
    v_mfma_f32_16x16x32_bf16 v[176:179], a[128:131], v[84:87], v[176:179]
    s_waitcnt vmcnt(9)
    ds_read_b64_tr_b16 a[144:145], v8 offset:24576
    v_cvt_pk_bf16_f32 v91, v66, v67
    v_mfma_f32_16x16x32_bf16 v[180:183], a[132:135], v[84:87], v[180:183]
    v_exp_f32 v68, v68
    v_mfma_f32_16x16x32_bf16 v[184:187], a[136:139], v[84:87], v[184:187]
    buffer_load_dwordx4 v17, s[16:19], s45 offen offset:1024 lds
    v_mfma_f32_16x16x32_bf16 v[188:191], a[140:143], v[84:87], v[188:191]
    s_waitcnt lgkmcnt(1)
    v_exp_f32 v69, v69
    v_mfma_f32_16x16x32_bf16 v[52:55], a[208:211], a[0:3], v[32:35]
    ds_read_b64_tr_b16 a[148:149], v9 offset:24576
    v_cvt_pk_bf16_f32 v92, v68, v69
    v_mfma_f32_16x16x32_bf16 v[52:55], a[212:215], a[4:7], v[52:55]
    buffer_load_dwordx4 v18, s[16:19], s45 offen offset:2048 lds
    v_mfma_f32_16x16x32_bf16 v[52:55], a[216:219], a[8:11], v[52:55]
    v_exp_f32 v70, v70
    v_mfma_f32_16x16x32_bf16 v[52:55], a[220:223], a[12:15], v[52:55]
    v_exp_f32 v71, v71
    v_mfma_f32_16x16x32_bf16 v[56:59], a[224:227], a[0:3], v[32:35]
    ds_read_b64_tr_b16 a[152:153], v10 offset:24576
    v_cvt_pk_bf16_f32 v93, v70, v71
    v_mfma_f32_16x16x32_bf16 v[56:59], a[228:231], a[4:7], v[56:59]
    v_exp_f32 v72, v72
    v_mfma_f32_16x16x32_bf16 v[56:59], a[232:235], a[8:11], v[56:59]
    buffer_load_dwordx4 v19, s[16:19], s45 offen offset:3072 lds
    v_mfma_f32_16x16x32_bf16 v[56:59], a[236:239], a[12:15], v[56:59]
    s_add_u32 m0, s31, 8192
    v_exp_f32 v73, v73
    v_mfma_f32_16x16x32_bf16 a[188:191], a[196:199], v[88:91], a[188:191]
    ds_read_b64_tr_b16 a[156:157], v11 offset:24576
    v_cvt_pk_bf16_f32 v94, v72, v73
    v_mfma_f32_16x16x32_bf16 v[192:195], a[112:115], v[88:91], v[192:195]
    v_exp_f32 v74, v74
    v_mfma_f32_16x16x32_bf16 v[196:199], a[116:119], v[88:91], v[196:199]
    buffer_load_dwordx4 v20, s[20:23], s44 offen lds
    v_mfma_f32_16x16x32_bf16 v[200:203], a[120:123], v[88:91], v[200:203]
    ds_read_b64_tr_b16 a[160:161], v12 offset:24576
    v_mfma_f32_16x16x32_bf16 v[204:207], a[124:127], v[88:91], v[204:207]
    v_exp_f32 v75, v75
    v_mfma_f32_16x16x32_bf16 v[208:211], a[128:131], v[88:91], v[208:211]
    ds_read_b64_tr_b16 a[164:165], v13 offset:24576
    v_cvt_pk_bf16_f32 v95, v74, v75
    v_mfma_f32_16x16x32_bf16 v[212:215], a[132:135], v[88:91], v[212:215]
    v_exp_f32 v52, v52
    v_mfma_f32_16x16x32_bf16 v[216:219], a[136:139], v[88:91], v[216:219]
    buffer_load_dwordx4 v21, s[20:23], s44 offen offset:1024 lds
    v_mfma_f32_16x16x32_bf16 v[220:223], a[140:143], v[88:91], v[220:223]
    ds_read_b64_tr_b16 a[168:169], v14 offset:24576
    v_mfma_f32_16x16x32_bf16 v[60:63], a[208:211], a[16:19], v[36:39]
    v_exp_f32 v53, v53
    v_mfma_f32_16x16x32_bf16 v[60:63], a[212:215], a[20:23], v[60:63]
    ds_read_b64_tr_b16 a[172:173], v15 offset:24576
    v_cvt_pk_bf16_f32 v76, v52, v53
    v_mfma_f32_16x16x32_bf16 v[60:63], a[216:219], a[24:27], v[60:63]
    v_exp_f32 v54, v54
    v_mfma_f32_16x16x32_bf16 v[60:63], a[220:223], a[28:31], v[60:63]
    buffer_load_dwordx4 v20, s[20:23], s44 offen offset:2048 lds
    v_mfma_f32_16x16x32_bf16 v[64:67], a[224:227], a[16:19], v[36:39]
    s_waitcnt vmcnt(11)
    ds_read_b64_tr_b16 a[146:147], v8 offset:28672
    v_mfma_f32_16x16x32_bf16 v[64:67], a[228:231], a[20:23], v[64:67]
    v_exp_f32 v55, v55
    v_mfma_f32_16x16x32_bf16 v[64:67], a[232:235], a[24:27], v[64:67]
    ds_read_b64_tr_b16 a[150:151], v9 offset:28672
    v_cvt_pk_bf16_f32 v77, v54, v55
    v_mfma_f32_16x16x32_bf16 v[64:67], a[236:239], a[28:31], v[64:67]
    v_exp_f32 v56, v56
    v_mfma_f32_16x16x32_bf16 a[192:195], a[196:199], v[92:95], a[192:195]
    buffer_load_dwordx4 v21, s[20:23], s44 offen offset:3072 lds
    v_mfma_f32_16x16x32_bf16 v[224:227], a[112:115], v[92:95], v[224:227]
    s_add_u32 m0, s31, 12288
    ds_read_b64_tr_b16 a[154:155], v10 offset:28672
    v_mfma_f32_16x16x32_bf16 v[228:231], a[116:119], v[92:95], v[228:231]
    v_exp_f32 v57, v57
    v_mfma_f32_16x16x32_bf16 v[232:235], a[120:123], v[92:95], v[232:235]
    ds_read_b64_tr_b16 a[158:159], v11 offset:28672
    v_cvt_pk_bf16_f32 v78, v56, v57
    v_mfma_f32_16x16x32_bf16 v[236:239], a[124:127], v[92:95], v[236:239]
    v_exp_f32 v58, v58
    v_mfma_f32_16x16x32_bf16 v[240:243], a[128:131], v[92:95], v[240:243]
    v_exp_f32 v59, v59
    v_mfma_f32_16x16x32_bf16 v[244:247], a[132:135], v[92:95], v[244:247]
    ds_read_b64_tr_b16 a[162:163], v12 offset:28672
    v_cvt_pk_bf16_f32 v79, v58, v59
    v_mfma_f32_16x16x32_bf16 v[248:251], a[136:139], v[92:95], v[248:251]
    buffer_load_dwordx4 v20, s[20:23], s45 offen lds
    v_mfma_f32_16x16x32_bf16 v[252:255], a[140:143], v[92:95], v[252:255]
    ds_read_b64_tr_b16 a[166:167], v13 offset:28672
    v_mfma_f32_16x16x32_bf16 v[68:71], a[208:211], a[32:35], v[40:43]
    v_exp_f32 v60, v60
    v_mfma_f32_16x16x32_bf16 v[68:71], a[212:215], a[36:39], v[68:71]
    ds_read_b64_tr_b16 a[170:171], v14 offset:28672
    v_mfma_f32_16x16x32_bf16 v[68:71], a[216:219], a[40:43], v[68:71]
    ds_read_b64_tr_b16 a[174:175], v15 offset:28672
    v_mfma_f32_16x16x32_bf16 v[68:71], a[220:223], a[44:47], v[68:71]
    buffer_load_dwordx4 v21, s[20:23], s45 offen offset:1024 lds
    v_mfma_f32_16x16x32_bf16 v[72:75], a[224:227], a[32:35], v[40:43]
    v_exp_f32 v61, v61
    v_mfma_f32_16x16x32_bf16 v[72:75], a[228:231], a[36:39], v[72:75]
    v_exp_f32 v62, v62
    v_mfma_f32_16x16x32_bf16 v[72:75], a[232:235], a[40:43], v[72:75]
    v_exp_f32 v63, v63
    v_mfma_f32_16x16x32_bf16 v[72:75], a[236:239], a[44:47], v[72:75]
    s_waitcnt lgkmcnt(0)
    v_cvt_pk_bf16_f32 v80, v60, v61
    v_cvt_pk_bf16_f32 v81, v62, v63
    v_mfma_f32_16x16x32_bf16 a[176:179], a[196:199], v[76:79], a[176:179]
    buffer_load_dwordx4 v20, s[20:23], s45 offen offset:2048 lds
    v_mfma_f32_16x16x32_bf16 v[96:99], a[144:147], v[76:79], v[96:99]
    v_exp_f32 v64, v64
    v_mfma_f32_16x16x32_bf16 v[100:103], a[148:151], v[76:79], v[100:103]
    v_exp_f32 v65, v65
    v_mfma_f32_16x16x32_bf16 v[104:107], a[152:155], v[76:79], v[104:107]
    buffer_load_dwordx4 v21, s[20:23], s45 offen offset:3072 lds
    v_mfma_f32_16x16x32_bf16 v[108:111], a[156:159], v[76:79], v[108:111]
    s_add_u32 m0, s31, 16384
    v_exp_f32 v66, v66
    v_mfma_f32_16x16x32_bf16 v[112:115], a[160:163], v[76:79], v[112:115]
    v_exp_f32 v67, v67
    v_mfma_f32_16x16x32_bf16 v[116:119], a[164:167], v[76:79], v[116:119]
    v_cvt_pk_bf16_f32 v82, v64, v65
    v_cvt_pk_bf16_f32 v83, v66, v67
    v_mfma_f32_16x16x32_bf16 v[120:123], a[168:171], v[76:79], v[120:123]
    buffer_load_dwordx4 v16, s[16:19], s46 offen lds
    v_mfma_f32_16x16x32_bf16 v[124:127], a[172:175], v[76:79], v[124:127]
    v_exp_f32 v68, v68
    v_mfma_f32_16x16x32_bf16 v[52:55], a[208:211], a[48:51], v[44:47]
    v_exp_f32 v69, v69
    v_mfma_f32_16x16x32_bf16 v[52:55], a[212:215], a[52:55], v[52:55]
    buffer_load_dwordx4 v17, s[16:19], s46 offen offset:1024 lds
    v_mfma_f32_16x16x32_bf16 v[52:55], a[216:219], a[56:59], v[52:55]
    v_exp_f32 v70, v70
    v_mfma_f32_16x16x32_bf16 v[52:55], a[220:223], a[60:63], v[52:55]
    v_exp_f32 v71, v71
    v_mfma_f32_16x16x32_bf16 v[56:59], a[224:227], a[48:51], v[44:47]
    s_waitcnt vmcnt(14)
    ds_read_b128 a[80:83], v4 offset:0
    v_cvt_pk_bf16_f32 v84, v68, v69
    v_mfma_f32_16x16x32_bf16 v[56:59], a[228:231], a[52:55], v[56:59]
    buffer_load_dwordx4 v18, s[16:19], s46 offen offset:2048 lds
    v_mfma_f32_16x16x32_bf16 v[56:59], a[232:235], a[56:59], v[56:59]
    v_exp_f32 v72, v72
    v_mfma_f32_16x16x32_bf16 v[56:59], a[236:239], a[60:63], v[56:59]
    ds_read_b128 a[84:87], v5 offset:0
    v_cvt_pk_bf16_f32 v85, v70, v71
    v_mfma_f32_16x16x32_bf16 a[180:183], a[196:199], v[80:83], a[180:183]
    v_exp_f32 v73, v73
    v_mfma_f32_16x16x32_bf16 v[128:131], a[144:147], v[80:83], v[128:131]
    v_exp_f32 v74, v74
    v_mfma_f32_16x16x32_bf16 v[132:135], a[148:151], v[80:83], v[132:135]
    buffer_load_dwordx4 v19, s[16:19], s46 offen offset:3072 lds
    v_mfma_f32_16x16x32_bf16 v[136:139], a[152:155], v[80:83], v[136:139]
    s_add_u32 m0, s31, 20480
    ds_read_b128 a[88:91], v6 offset:0
    v_cvt_pk_bf16_f32 v86, v72, v73
    v_mfma_f32_16x16x32_bf16 v[140:143], a[156:159], v[80:83], v[140:143]
    v_exp_f32 v75, v75
    v_mfma_f32_16x16x32_bf16 v[144:147], a[160:163], v[80:83], v[144:147]
    ds_read_b128 a[92:95], v7 offset:0
    v_cvt_pk_bf16_f32 v87, v74, v75
    v_mfma_f32_16x16x32_bf16 v[148:151], a[164:167], v[80:83], v[148:151]
    v_exp_f32 v52, v52
    v_mfma_f32_16x16x32_bf16 v[152:155], a[168:171], v[80:83], v[152:155]
    buffer_load_dwordx4 v16, s[16:19], s47 offen lds
    v_mfma_f32_16x16x32_bf16 v[156:159], a[172:175], v[80:83], v[156:159]
    v_exp_f32 v53, v53
    v_mfma_f32_16x16x32_bf16 v[60:63], a[208:211], a[64:67], v[48:51]
    s_waitcnt vmcnt(13)
    ds_read_b128 a[96:99], v4 offset:4096
    v_cvt_pk_bf16_f32 v88, v52, v53
    v_mfma_f32_16x16x32_bf16 v[60:63], a[212:215], a[68:71], v[60:63]
    v_exp_f32 v54, v54
    v_mfma_f32_16x16x32_bf16 v[60:63], a[216:219], a[72:75], v[60:63]
    buffer_load_dwordx4 v17, s[16:19], s47 offen offset:1024 lds
    v_mfma_f32_16x16x32_bf16 v[60:63], a[220:223], a[76:79], v[60:63]
    v_exp_f32 v55, v55
    v_mfma_f32_16x16x32_bf16 v[64:67], a[224:227], a[64:67], v[48:51]
    ds_read_b128 a[100:103], v5 offset:4096
    v_cvt_pk_bf16_f32 v89, v54, v55
    v_mfma_f32_16x16x32_bf16 v[64:67], a[228:231], a[68:71], v[64:67]
    v_exp_f32 v56, v56
    v_mfma_f32_16x16x32_bf16 v[64:67], a[232:235], a[72:75], v[64:67]
    v_exp_f32 v57, v57
    v_mfma_f32_16x16x32_bf16 v[64:67], a[236:239], a[76:79], v[64:67]
    ds_read_b128 a[104:107], v6 offset:4096
    v_cvt_pk_bf16_f32 v90, v56, v57
    v_mfma_f32_16x16x32_bf16 a[184:187], a[196:199], v[84:87], a[184:187]
    buffer_load_dwordx4 v18, s[16:19], s47 offen offset:2048 lds
    v_mfma_f32_16x16x32_bf16 v[160:163], a[144:147], v[84:87], v[160:163]
    v_exp_f32 v58, v58
    v_mfma_f32_16x16x32_bf16 v[164:167], a[148:151], v[84:87], v[164:167]
    v_exp_f32 v59, v59
    v_mfma_f32_16x16x32_bf16 v[168:171], a[152:155], v[84:87], v[168:171]
    ds_read_b128 a[108:111], v7 offset:4096
    v_cvt_pk_bf16_f32 v91, v58, v59
    v_mfma_f32_16x16x32_bf16 v[172:175], a[156:159], v[84:87], v[172:175]
    buffer_load_dwordx4 v19, s[16:19], s47 offen offset:3072 lds
    v_mfma_f32_16x16x32_bf16 v[176:179], a[160:163], v[84:87], v[176:179]
    s_add_u32 m0, s31, 24576
    v_exp_f32 v60, v60
    v_mfma_f32_16x16x32_bf16 v[180:183], a[164:167], v[84:87], v[180:183]
    v_exp_f32 v61, v61
    v_mfma_f32_16x16x32_bf16 v[184:187], a[168:171], v[84:87], v[184:187]
    s_waitcnt vmcnt(12)
    ds_read_b64_tr_b16 a[112:113], v8 offset:8192
    v_cvt_pk_bf16_f32 v92, v60, v61
    v_mfma_f32_16x16x32_bf16 v[188:191], a[172:175], v[84:87], v[188:191]
    s_waitcnt lgkmcnt(1)
    buffer_load_dwordx4 v20, s[20:23], s46 offen lds
    v_mfma_f32_16x16x32_bf16 v[68:71], a[80:83], a[0:3], v[32:35]
    v_exp_f32 v62, v62
    v_mfma_f32_16x16x32_bf16 v[68:71], a[84:87], a[4:7], v[68:71]
    v_exp_f32 v63, v63
    v_mfma_f32_16x16x32_bf16 v[68:71], a[88:91], a[8:11], v[68:71]
    ds_read_b64_tr_b16 a[116:117], v9 offset:8192
    v_cvt_pk_bf16_f32 v93, v62, v63
    v_mfma_f32_16x16x32_bf16 v[68:71], a[92:95], a[12:15], v[68:71]
L_hop2:
    s_cbranch_execz L_back
    v_exp_f32 v64, v64
    v_mfma_f32_16x16x32_bf16 v[72:75], a[96:99], a[0:3], v[32:35]
    buffer_load_dwordx4 v21, s[20:23], s46 offen offset:1024 lds
    v_mfma_f32_16x16x32_bf16 v[72:75], a[100:103], a[4:7], v[72:75]
    v_exp_f32 v65, v65
    v_mfma_f32_16x16x32_bf16 v[72:75], a[104:107], a[8:11], v[72:75]
    ds_read_b64_tr_b16 a[120:121], v10 offset:8192
    v_cvt_pk_bf16_f32 v94, v64, v65
    v_mfma_f32_16x16x32_bf16 v[72:75], a[108:111], a[12:15], v[72:75]
    v_exp_f32 v66, v66
    v_mfma_f32_16x16x32_bf16 a[188:191], a[196:199], v[88:91], a[188:191]
    ds_read_b64_tr_b16 a[124:125], v11 offset:8192
    v_mfma_f32_16x16x32_bf16 v[192:195], a[144:147], v[88:91], v[192:195]
    buffer_load_dwordx4 v20, s[20:23], s46 offen offset:2048 lds
    v_mfma_f32_16x16x32_bf16 v[196:199], a[148:151], v[88:91], v[196:199]
    v_exp_f32 v67, v67
    v_mfma_f32_16x16x32_bf16 v[200:203], a[152:155], v[88:91], v[200:203]
    ds_read_b64_tr_b16 a[128:129], v12 offset:8192
    v_cvt_pk_bf16_f32 v95, v66, v67
    v_mfma_f32_16x16x32_bf16 v[204:207], a[156:159], v[88:91], v[204:207]
    v_exp_f32 v68, v68
    v_mfma_f32_16x16x32_bf16 v[208:211], a[160:163], v[88:91], v[208:211]
    ds_read_b64_tr_b16 a[132:133], v13 offset:8192
    v_mfma_f32_16x16x32_bf16 v[212:215], a[164:167], v[88:91], v[212:215]
    buffer_load_dwordx4 v21, s[20:23], s46 offen offset:3072 lds
    v_mfma_f32_16x16x32_bf16 v[216:219], a[168:171], v[88:91], v[216:219]
    s_add_u32 m0, s31, 28672
    v_exp_f32 v69, v69
    v_mfma_f32_16x16x32_bf16 v[220:223], a[172:175], v[88:91], v[220:223]
    ds_read_b64_tr_b16 a[136:137], v14 offset:8192
    v_cvt_pk_bf16_f32 v76, v68, v69
    v_mfma_f32_16x16x32_bf16 v[52:55], a[80:83], a[16:19], v[36:39]
    v_exp_f32 v70, v70
    v_mfma_f32_16x16x32_bf16 v[52:55], a[84:87], a[20:23], v[52:55]
    ds_read_b64_tr_b16 a[140:141], v15 offset:8192
    v_mfma_f32_16x16x32_bf16 v[52:55], a[88:91], a[24:27], v[52:55]
    buffer_load_dwordx4 v20, s[20:23], s47 offen lds
    v_mfma_f32_16x16x32_bf16 v[52:55], a[92:95], a[28:31], v[52:55]
    v_exp_f32 v71, v71
    v_mfma_f32_16x16x32_bf16 v[56:59], a[96:99], a[16:19], v[36:39]
    s_waitcnt vmcnt(13)
    ds_read_b64_tr_b16 a[114:115], v8 offset:12288
    v_cvt_pk_bf16_f32 v77, v70, v71
    v_mfma_f32_16x16x32_bf16 v[56:59], a[100:103], a[20:23], v[56:59]
    buffer_load_dwordx4 v21, s[20:23], s47 offen offset:1024 lds
    v_mfma_f32_16x16x32_bf16 v[56:59], a[104:107], a[24:27], v[56:59]
    ds_read_b64_tr_b16 a[118:119], v9 offset:12288
    v_mfma_f32_16x16x32_bf16 v[56:59], a[108:111], a[28:31], v[56:59]
    v_exp_f32 v72, v72
    v_mfma_f32_16x16x32_bf16 a[192:195], a[196:199], v[92:95], a[192:195]
    v_exp_f32 v73, v73
    v_mfma_f32_16x16x32_bf16 v[224:227], a[144:147], v[92:95], v[224:227]
    ds_read_b64_tr_b16 a[122:123], v10 offset:12288
    v_cvt_pk_bf16_f32 v78, v72, v73
    v_mfma_f32_16x16x32_bf16 v[228:231], a[148:151], v[92:95], v[228:231]
    v_exp_f32 v74, v74
    v_mfma_f32_16x16x32_bf16 v[232:235], a[152:155], v[92:95], v[232:235]
    ds_read_b64_tr_b16 a[126:127], v11 offset:12288
    v_mfma_f32_16x16x32_bf16 v[236:239], a[156:159], v[92:95], v[236:239]
    buffer_load_dwordx4 v20, s[20:23], s47 offen offset:2048 lds
    v_mfma_f32_16x16x32_bf16 v[240:243], a[160:163], v[92:95], v[240:243]
    v_exp_f32 v75, v75
    v_mfma_f32_16x16x32_bf16 v[244:247], a[164:167], v[92:95], v[244:247]
    ds_read_b64_tr_b16 a[130:131], v12 offset:12288
    v_cvt_pk_bf16_f32 v79, v74, v75
    v_mfma_f32_16x16x32_bf16 v[248:251], a[168:171], v[92:95], v[248:251]
    v_exp_f32 v52, v52
    v_mfma_f32_16x16x32_bf16 v[252:255], a[172:175], v[92:95], v[252:255]
    ds_read_b64_tr_b16 a[134:135], v13 offset:12288
    v_mfma_f32_16x16x32_bf16 v[60:63], a[80:83], a[32:35], v[40:43]
    buffer_load_dwordx4 v21, s[20:23], s47 offen offset:3072 lds
    v_mfma_f32_16x16x32_bf16 v[60:63], a[84:87], a[36:39], v[60:63]
    s_mov_b32 m0, s31
    ds_read_b64_tr_b16 a[138:139], v14 offset:12288
    v_mfma_f32_16x16x32_bf16 v[60:63], a[88:91], a[40:43], v[60:63]
    ds_read_b64_tr_b16 a[142:143], v15 offset:12288
    v_mfma_f32_16x16x32_bf16 v[60:63], a[92:95], a[44:47], v[60:63]
    v_exp_f32 v53, v53
    v_mfma_f32_16x16x32_bf16 v[64:67], a[96:99], a[32:35], v[40:43]
    v_exp_f32 v54, v54
    v_mfma_f32_16x16x32_bf16 v[64:67], a[100:103], a[36:39], v[64:67]
    buffer_load_dwordx4 v16, s[16:19], s48 offen lds
    v_mfma_f32_16x16x32_bf16 v[64:67], a[104:107], a[40:43], v[64:67]
    v_exp_f32 v55, v55
    v_mfma_f32_16x16x32_bf16 v[64:67], a[108:111], a[44:47], v[64:67]
    s_waitcnt lgkmcnt(0)
    v_cvt_pk_bf16_f32 v80, v52, v53
    v_cvt_pk_bf16_f32 v81, v54, v55
    v_mfma_f32_16x16x32_bf16 a[176:179], a[196:199], v[76:79], a[176:179]
    v_exp_f32 v56, v56
    v_mfma_f32_16x16x32_bf16 v[96:99], a[112:115], v[76:79], v[96:99]
    buffer_load_dwordx4 v17, s[16:19], s48 offen offset:1024 lds
    v_mfma_f32_16x16x32_bf16 v[100:103], a[116:119], v[76:79], v[100:103]
    v_exp_f32 v57, v57
    v_mfma_f32_16x16x32_bf16 v[104:107], a[120:123], v[76:79], v[104:107]
    v_exp_f32 v58, v58
    v_mfma_f32_16x16x32_bf16 v[108:111], a[124:127], v[76:79], v[108:111]
    buffer_load_dwordx4 v18, s[16:19], s48 offen offset:2048 lds
    v_mfma_f32_16x16x32_bf16 v[112:115], a[128:131], v[76:79], v[112:115]
    v_exp_f32 v59, v59
    v_mfma_f32_16x16x32_bf16 v[116:119], a[132:135], v[76:79], v[116:119]
    v_cvt_pk_bf16_f32 v82, v56, v57
    v_cvt_pk_bf16_f32 v83, v58, v59
    v_mfma_f32_16x16x32_bf16 v[120:123], a[136:139], v[76:79], v[120:123]
    v_exp_f32 v60, v60
    v_mfma_f32_16x16x32_bf16 v[124:127], a[140:143], v[76:79], v[124:127]
    buffer_load_dwordx4 v19, s[16:19], s48 offen offset:3072 lds
    v_mfma_f32_16x16x32_bf16 v[68:71], a[80:83], a[48:51], v[44:47]
    s_add_u32 m0, s31, 4096
    v_exp_f32 v61, v61
    v_mfma_f32_16x16x32_bf16 v[68:71], a[84:87], a[52:55], v[68:71]
    v_exp_f32 v62, v62
    v_mfma_f32_16x16x32_bf16 v[68:71], a[88:91], a[56:59], v[68:71]
    v_exp_f32 v63, v63
    v_mfma_f32_16x16x32_bf16 v[68:71], a[92:95], a[60:63], v[68:71]
    v_cvt_pk_bf16_f32 v84, v60, v61
    v_cvt_pk_bf16_f32 v85, v62, v63
    v_mfma_f32_16x16x32_bf16 v[72:75], a[96:99], a[48:51], v[44:47]
    buffer_load_dwordx4 v16, s[16:19], s49 offen lds
    v_mfma_f32_16x16x32_bf16 v[72:75], a[100:103], a[52:55], v[72:75]
    v_exp_f32 v64, v64
    v_mfma_f32_16x16x32_bf16 v[72:75], a[104:107], a[56:59], v[72:75]
    v_exp_f32 v65, v65
    v_mfma_f32_16x16x32_bf16 v[72:75], a[108:111], a[60:63], v[72:75]
    s_waitcnt vmcnt(17)
    ds_read_b128 a[208:211], v4 offset:16384
    v_cvt_pk_bf16_f32 v86, v64, v65
    v_mfma_f32_16x16x32_bf16 a[180:183], a[196:199], v[80:83], a[180:183]
    buffer_load_dwordx4 v17, s[16:19], s49 offen offset:1024 lds
    v_mfma_f32_16x16x32_bf16 v[128:131], a[112:115], v[80:83], v[128:131]
    v_exp_f32 v66, v66
    v_mfma_f32_16x16x32_bf16 v[132:135], a[116:119], v[80:83], v[132:135]
    v_exp_f32 v67, v67
    v_mfma_f32_16x16x32_bf16 v[136:139], a[120:123], v[80:83], v[136:139]
    ds_read_b128 a[212:215], v5 offset:16384
    v_cvt_pk_bf16_f32 v87, v66, v67
    v_mfma_f32_16x16x32_bf16 v[140:143], a[124:127], v[80:83], v[140:143]
    v_exp_f32 v68, v68
    v_mfma_f32_16x16x32_bf16 v[144:147], a[128:131], v[80:83], v[144:147]
    buffer_load_dwordx4 v18, s[16:19], s49 offen offset:2048 lds
    v_mfma_f32_16x16x32_bf16 v[148:151], a[132:135], v[80:83], v[148:151]
    v_exp_f32 v69, v69
    v_mfma_f32_16x16x32_bf16 v[152:155], a[136:139], v[80:83], v[152:155]
    ds_read_b128 a[216:219], v6 offset:16384
    v_cvt_pk_bf16_f32 v88, v68, v69
    v_mfma_f32_16x16x32_bf16 v[156:159], a[140:143], v[80:83], v[156:159]
    v_exp_f32 v70, v70
    v_mfma_f32_16x16x32_bf16 v[52:55], a[80:83], a[64:67], v[48:51]
    buffer_load_dwordx4 v19, s[16:19], s49 offen offset:3072 lds
    v_mfma_f32_16x16x32_bf16 v[52:55], a[84:87], a[68:71], v[52:55]
    s_add_u32 m0, s31, 8192
    ds_read_b128 a[220:223], v7 offset:16384
    v_mfma_f32_16x16x32_bf16 v[52:55], a[88:91], a[72:75], v[52:55]
    v_exp_f32 v71, v71
    v_mfma_f32_16x16x32_bf16 v[52:55], a[92:95], a[76:79], v[52:55]
    s_waitcnt vmcnt(16)
    ds_read_b128 a[224:227], v4 offset:20480
    v_cvt_pk_bf16_f32 v89, v70, v71
    v_mfma_f32_16x16x32_bf16 v[56:59], a[96:99], a[64:67], v[48:51]
    v_exp_f32 v72, v72
    v_mfma_f32_16x16x32_bf16 v[56:59], a[100:103], a[68:71], v[56:59]
    buffer_load_dwordx4 v20, s[20:23], s48 offen lds
    v_mfma_f32_16x16x32_bf16 v[56:59], a[104:107], a[72:75], v[56:59]
    v_exp_f32 v73, v73
    v_mfma_f32_16x16x32_bf16 v[56:59], a[108:111], a[76:79], v[56:59]
    ds_read_b128 a[228:231], v5 offset:20480
    v_cvt_pk_bf16_f32 v90, v72, v73
    v_mfma_f32_16x16x32_bf16 a[184:187], a[196:199], v[84:87], a[184:187]
    v_exp_f32 v74, v74
    v_mfma_f32_16x16x32_bf16 v[160:163], a[112:115], v[84:87], v[160:163]
    buffer_load_dwordx4 v21, s[20:23], s48 offen offset:1024 lds
    v_mfma_f32_16x16x32_bf16 v[164:167], a[116:119], v[84:87], v[164:167]
    ds_read_b128 a[232:235], v6 offset:20480
    v_mfma_f32_16x16x32_bf16 v[168:171], a[120:123], v[84:87], v[168:171]
    ds_read_b128 a[236:239], v7 offset:20480
    v_mfma_f32_16x16x32_bf16 v[172:175], a[124:127], v[84:87], v[172:175]
    v_exp_f32 v75, v75
    v_mfma_f32_16x16x32_bf16 v[176:179], a[128:131], v[84:87], v[176:179]
    s_waitcnt vmcnt(14)
    ds_read_b64_tr_b16 a[144:145], v8 offset:24576
    v_cvt_pk_bf16_f32 v91, v74, v75
    v_mfma_f32_16x16x32_bf16 v[180:183], a[132:135], v[84:87], v[180:183]
    v_exp_f32 v52, v52
    v_mfma_f32_16x16x32_bf16 v[184:187], a[136:139], v[84:87], v[184:187]
    buffer_load_dwordx4 v20, s[20:23], s48 offen offset:2048 lds
    v_mfma_f32_16x16x32_bf16 v[188:191], a[140:143], v[84:87], v[188:191]
    s_waitcnt lgkmcnt(1)
    v_exp_f32 v53, v53
    v_mfma_f32_16x16x32_bf16 v[60:63], a[208:211], a[0:3], v[32:35]
    ds_read_b64_tr_b16 a[148:149], v9 offset:24576
    v_cvt_pk_bf16_f32 v92, v52, v53
    v_mfma_f32_16x16x32_bf16 v[60:63], a[212:215], a[4:7], v[60:63]
    v_exp_f32 v54, v54
    v_mfma_f32_16x16x32_bf16 v[60:63], a[216:219], a[8:11], v[60:63]
    buffer_load_dwordx4 v21, s[20:23], s48 offen offset:3072 lds
    v_mfma_f32_16x16x32_bf16 v[60:63], a[220:223], a[12:15], v[60:63]
    s_add_u32 m0, s31, 12288
    v_exp_f32 v55, v55
    v_mfma_f32_16x16x32_bf16 v[64:67], a[224:227], a[0:3], v[32:35]
    ds_read_b64_tr_b16 a[152:153], v10 offset:24576
    v_cvt_pk_bf16_f32 v93, v54, v55
    v_mfma_f32_16x16x32_bf16 v[64:67], a[228:231], a[4:7], v[64:67]
    v_exp_f32 v56, v56
    v_mfma_f32_16x16x32_bf16 v[64:67], a[232:235], a[8:11], v[64:67]
    buffer_load_dwordx4 v20, s[20:23], s49 offen lds
    v_mfma_f32_16x16x32_bf16 v[64:67], a[236:239], a[12:15], v[64:67]
    v_exp_f32 v57, v57
    v_mfma_f32_16x16x32_bf16 a[188:191], a[196:199], v[88:91], a[188:191]
    ds_read_b64_tr_b16 a[156:157], v11 offset:24576
    v_cvt_pk_bf16_f32 v94, v56, v57
    v_mfma_f32_16x16x32_bf16 v[192:195], a[112:115], v[88:91], v[192:195]
    v_exp_f32 v58, v58
    v_mfma_f32_16x16x32_bf16 v[196:199], a[116:119], v[88:91], v[196:199]
    v_exp_f32 v59, v59
    v_mfma_f32_16x16x32_bf16 v[200:203], a[120:123], v[88:91], v[200:203]
    ds_read_b64_tr_b16 a[160:161], v12 offset:24576
    v_cvt_pk_bf16_f32 v95, v58, v59
    v_mfma_f32_16x16x32_bf16 v[204:207], a[124:127], v[88:91], v[204:207]
    buffer_load_dwordx4 v21, s[20:23], s49 offen offset:1024 lds
    v_mfma_f32_16x16x32_bf16 v[208:211], a[128:131], v[88:91], v[208:211]
    ds_read_b64_tr_b16 a[164:165], v13 offset:24576
    v_mfma_f32_16x16x32_bf16 v[212:215], a[132:135], v[88:91], v[212:215]
    v_exp_f32 v60, v60
    v_mfma_f32_16x16x32_bf16 v[216:219], a[136:139], v[88:91], v[216:219]
    buffer_load_dwordx4 v20, s[20:23], s49 offen offset:2048 lds
    v_mfma_f32_16x16x32_bf16 v[220:223], a[140:143], v[88:91], v[220:223]
    ds_read_b64_tr_b16 a[168:169], v14 offset:24576
    v_mfma_f32_16x16x32_bf16 v[68:71], a[208:211], a[16:19], v[36:39]
    v_exp_f32 v61, v61
    v_mfma_f32_16x16x32_bf16 v[68:71], a[212:215], a[20:23], v[68:71]
    ds_read_b64_tr_b16 a[172:173], v15 offset:24576
    v_cvt_pk_bf16_f32 v76, v60, v61
    v_mfma_f32_16x16x32_bf16 v[68:71], a[216:219], a[24:27], v[68:71]
    v_exp_f32 v62, v62
    v_mfma_f32_16x16x32_bf16 v[68:71], a[220:223], a[28:31], v[68:71]
    buffer_load_dwordx4 v21, s[20:23], s49 offen offset:3072 lds
    v_mfma_f32_16x16x32_bf16 v[72:75], a[224:227], a[16:19], v[36:39]
    s_add_u32 m0, s31, 16384
    s_waitcnt vmcnt(16)
    ds_read_b64_tr_b16 a[146:147], v8 offset:28672
    v_mfma_f32_16x16x32_bf16 v[72:75], a[228:231], a[20:23], v[72:75]
    v_exp_f32 v63, v63
    v_mfma_f32_16x16x32_bf16 v[72:75], a[232:235], a[24:27], v[72:75]
    ds_read_b64_tr_b16 a[150:151], v9 offset:28672
    v_cvt_pk_bf16_f32 v77, v62, v63
    v_mfma_f32_16x16x32_bf16 v[72:75], a[236:239], a[28:31], v[72:75]
    v_exp_f32 v64, v64
    v_mfma_f32_16x16x32_bf16 a[192:195], a[196:199], v[92:95], a[192:195]
    v_exp_f32 v65, v65
    v_mfma_f32_16x16x32_bf16 v[224:227], a[112:115], v[92:95], v[224:227]
    ds_read_b64_tr_b16 a[154:155], v10 offset:28672
    v_cvt_pk_bf16_f32 v78, v64, v65
    v_mfma_f32_16x16x32_bf16 v[228:231], a[116:119], v[92:95], v[228:231]
    buffer_load_dwordx4 v16, s[16:19], s50 offen lds
    v_mfma_f32_16x16x32_bf16 v[232:235], a[120:123], v[92:95], v[232:235]
    ds_read_b64_tr_b16 a[158:159], v11 offset:28672
    v_mfma_f32_16x16x32_bf16 v[236:239], a[124:127], v[92:95], v[236:239]
    v_exp_f32 v66, v66
    v_mfma_f32_16x16x32_bf16 v[240:243], a[128:131], v[92:95], v[240:243]
    v_exp_f32 v67, v67
    v_mfma_f32_16x16x32_bf16 v[244:247], a[132:135], v[92:95], v[244:247]
    ds_read_b64_tr_b16 a[162:163], v12 offset:28672
    v_cvt_pk_bf16_f32 v79, v66, v67
    v_mfma_f32_16x16x32_bf16 v[248:251], a[136:139], v[92:95], v[248:251]
    buffer_load_dwordx4 v17, s[16:19], s50 offen offset:1024 lds
    v_mfma_f32_16x16x32_bf16 v[252:255], a[140:143], v[92:95], v[252:255]
    ds_read_b64_tr_b16 a[166:167], v13 offset:28672
    v_mfma_f32_16x16x32_bf16 v[52:55], a[208:211], a[32:35], v[40:43]
    v_exp_f32 v68, v68
    v_mfma_f32_16x16x32_bf16 v[52:55], a[212:215], a[36:39], v[52:55]
    ds_read_b64_tr_b16 a[170:171], v14 offset:28672
    v_mfma_f32_16x16x32_bf16 v[52:55], a[216:219], a[40:43], v[52:55]
    ds_read_b64_tr_b16 a[174:175], v15 offset:28672
    v_mfma_f32_16x16x32_bf16 v[52:55], a[220:223], a[44:47], v[52:55]
    v_exp_f32 v69, v69
    v_mfma_f32_16x16x32_bf16 v[56:59], a[224:227], a[32:35], v[40:43]
    buffer_load_dwordx4 v18, s[16:19], s50 offen offset:2048 lds
    v_mfma_f32_16x16x32_bf16 v[56:59], a[228:231], a[36:39], v[56:59]
    v_exp_f32 v70, v70
    v_mfma_f32_16x16x32_bf16 v[56:59], a[232:235], a[40:43], v[56:59]
    v_exp_f32 v71, v71
    v_mfma_f32_16x16x32_bf16 v[56:59], a[236:239], a[44:47], v[56:59]
    s_waitcnt lgkmcnt(0)
    v_cvt_pk_bf16_f32 v80, v68, v69
    v_cvt_pk_bf16_f32 v81, v70, v71
    v_mfma_f32_16x16x32_bf16 a[176:179], a[196:199], v[76:79], a[176:179]
    buffer_load_dwordx4 v19, s[16:19], s50 offen offset:3072 lds
    v_mfma_f32_16x16x32_bf16 v[96:99], a[144:147], v[76:79], v[96:99]
    s_add_u32 m0, s31, 20480
    v_exp_f32 v72, v72
    v_mfma_f32_16x16x32_bf16 v[100:103], a[148:151], v[76:79], v[100:103]
    v_exp_f32 v73, v73
    v_mfma_f32_16x16x32_bf16 v[104:107], a[152:155], v[76:79], v[104:107]
    buffer_load_dwordx4 v16, s[16:19], s51 offen lds
    v_mfma_f32_16x16x32_bf16 v[108:111], a[156:159], v[76:79], v[108:111]
    v_exp_f32 v74, v74
    v_mfma_f32_16x16x32_bf16 v[112:115], a[160:163], v[76:79], v[112:115]
    v_exp_f32 v75, v75
    v_mfma_f32_16x16x32_bf16 v[116:119], a[164:167], v[76:79], v[116:119]
    v_cvt_pk_bf16_f32 v82, v72, v73
    v_cvt_pk_bf16_f32 v83, v74, v75
    v_mfma_f32_16x16x32_bf16 v[120:123], a[168:171], v[76:79], v[120:123]
    v_exp_f32 v52, v52
    v_mfma_f32_16x16x32_bf16 v[124:127], a[172:175], v[76:79], v[124:127]
    buffer_load_dwordx4 v17, s[16:19], s51 offen offset:1024 lds
    v_mfma_f32_16x16x32_bf16 v[60:63], a[208:211], a[48:51], v[44:47]
    v_exp_f32 v53, v53
    v_mfma_f32_16x16x32_bf16 v[60:63], a[212:215], a[52:55], v[60:63]
    buffer_load_dwordx4 v18, s[16:19], s51 offen offset:2048 lds
    v_mfma_f32_16x16x32_bf16 v[60:63], a[216:219], a[56:59], v[60:63]
    v_exp_f32 v54, v54
    v_mfma_f32_16x16x32_bf16 v[60:63], a[220:223], a[60:63], v[60:63]
    v_exp_f32 v55, v55
    v_mfma_f32_16x16x32_bf16 v[64:67], a[224:227], a[48:51], v[44:47]
    s_waitcnt vmcnt(19)
    ds_read_b128 a[80:83], v4 offset:0
    v_cvt_pk_bf16_f32 v84, v52, v53
    v_mfma_f32_16x16x32_bf16 v[64:67], a[228:231], a[52:55], v[64:67]
    v_exp_f32 v56, v56
    v_mfma_f32_16x16x32_bf16 v[64:67], a[232:235], a[56:59], v[64:67]
    buffer_load_dwordx4 v19, s[16:19], s51 offen offset:3072 lds
    v_mfma_f32_16x16x32_bf16 v[64:67], a[236:239], a[60:63], v[64:67]
    s_add_u32 m0, s31, 24576
    ds_read_b128 a[84:87], v5 offset:0
    v_cvt_pk_bf16_f32 v85, v54, v55
    v_mfma_f32_16x16x32_bf16 a[180:183], a[196:199], v[80:83], a[180:183]
    v_exp_f32 v57, v57
    v_mfma_f32_16x16x32_bf16 v[128:131], a[144:147], v[80:83], v[128:131]
    v_exp_f32 v58, v58
    v_mfma_f32_16x16x32_bf16 v[132:135], a[148:151], v[80:83], v[132:135]
    buffer_load_dwordx4 v20, s[20:23], s50 offen lds
    v_mfma_f32_16x16x32_bf16 v[136:139], a[152:155], v[80:83], v[136:139]
    ds_read_b128 a[88:91], v6 offset:0
    v_cvt_pk_bf16_f32 v86, v56, v57
    v_mfma_f32_16x16x32_bf16 v[140:143], a[156:159], v[80:83], v[140:143]
    v_exp_f32 v59, v59
    v_mfma_f32_16x16x32_bf16 v[144:147], a[160:163], v[80:83], v[144:147]
    ds_read_b128 a[92:95], v7 offset:0
    v_cvt_pk_bf16_f32 v87, v58, v59
    v_mfma_f32_16x16x32_bf16 v[148:151], a[164:167], v[80:83], v[148:151]
    v_exp_f32 v60, v60
    v_mfma_f32_16x16x32_bf16 v[152:155], a[168:171], v[80:83], v[152:155]
    buffer_load_dwordx4 v21, s[20:23], s50 offen offset:1024 lds
    v_mfma_f32_16x16x32_bf16 v[156:159], a[172:175], v[80:83], v[156:159]
    v_exp_f32 v61, v61
    v_mfma_f32_16x16x32_bf16 v[68:71], a[208:211], a[64:67], v[48:51]
    s_waitcnt vmcnt(18)
    ds_read_b128 a[96:99], v4 offset:4096
    v_cvt_pk_bf16_f32 v88, v60, v61
    v_mfma_f32_16x16x32_bf16 v[68:71], a[212:215], a[68:71], v[68:71]
    v_exp_f32 v62, v62
    v_mfma_f32_16x16x32_bf16 v[68:71], a[216:219], a[72:75], v[68:71]
    v_exp_f32 v63, v63
    v_mfma_f32_16x16x32_bf16 v[68:71], a[220:223], a[76:79], v[68:71]
    ds_read_b128 a[100:103], v5 offset:4096
    v_cvt_pk_bf16_f32 v89, v62, v63
    v_mfma_f32_16x16x32_bf16 v[72:75], a[224:227], a[64:67], v[48:51]
    buffer_load_dwordx4 v20, s[20:23], s50 offen offset:2048 lds
    v_mfma_f32_16x16x32_bf16 v[72:75], a[228:231], a[68:71], v[72:75]
    v_exp_f32 v64, v64
    v_mfma_f32_16x16x32_bf16 v[72:75], a[232:235], a[72:75], v[72:75]
    v_exp_f32 v65, v65
    v_mfma_f32_16x16x32_bf16 v[72:75], a[236:239], a[76:79], v[72:75]
    s_waitcnt vmcnt(7)
    ds_read_b128 a[208:211], v4 offset:16384
    v_cvt_pk_bf16_f32 v90, v64, v65
    v_mfma_f32_16x16x32_bf16 a[184:187], a[196:199], v[84:87], a[184:187]
    buffer_load_dwordx4 v21, s[20:23], s50 offen offset:3072 lds
    v_mfma_f32_16x16x32_bf16 v[160:163], a[144:147], v[84:87], v[160:163]
    s_add_u32 m0, s31, 28672
    v_exp_f32 v66, v66
    v_mfma_f32_16x16x32_bf16 v[164:167], a[148:151], v[84:87], v[164:167]
    ds_read_b128 a[104:107], v6 offset:4096
    v_mfma_f32_16x16x32_bf16 v[168:171], a[152:155], v[84:87], v[168:171]
    ds_read_b128 a[108:111], v7 offset:4096
    v_mfma_f32_16x16x32_bf16 v[172:175], a[156:159], v[84:87], v[172:175]
    ds_read_b128 a[212:215], v5 offset:16384
    v_mfma_f32_16x16x32_bf16 v[176:179], a[160:163], v[84:87], v[176:179]
    v_exp_f32 v67, v67
    v_mfma_f32_16x16x32_bf16 v[180:183], a[164:167], v[84:87], v[180:183]
    ds_read_b128 a[216:219], v6 offset:16384
    v_cvt_pk_bf16_f32 v91, v66, v67
    v_mfma_f32_16x16x32_bf16 v[184:187], a[168:171], v[84:87], v[184:187]
    buffer_load_dwordx4 v20, s[20:23], s51 offen lds
    v_mfma_f32_16x16x32_bf16 v[188:191], a[172:175], v[84:87], v[188:191]
    s_waitcnt lgkmcnt(2)
    v_exp_f32 v68, v68
    v_mfma_f32_16x16x32_bf16 v[52:55], a[80:83], a[0:3], v[32:35]
    buffer_load_dwordx4 v21, s[20:23], s51 offen offset:1024 lds
    v_mfma_f32_16x16x32_bf16 v[52:55], a[84:87], a[4:7], v[52:55]
    ds_read_b64_tr_b16 a[112:113], v8 offset:8192
    v_mfma_f32_16x16x32_bf16 v[52:55], a[88:91], a[8:11], v[52:55]
    ds_read_b128 a[220:223], v7 offset:16384
    v_mfma_f32_16x16x32_bf16 v[52:55], a[92:95], a[12:15], v[52:55]
    ds_read_b64_tr_b16 a[116:117], v9 offset:8192
    v_exp_f32 v69, v69
    v_mfma_f32_16x16x32_bf16 v[56:59], a[96:99], a[0:3], v[32:35]
    s_waitcnt vmcnt(6)
    ds_read_b128 a[224:227], v4 offset:20480
    v_cvt_pk_bf16_f32 v92, v68, v69
    v_mfma_f32_16x16x32_bf16 v[56:59], a[100:103], a[4:7], v[56:59]
    v_exp_f32 v70, v70
    v_mfma_f32_16x16x32_bf16 v[56:59], a[104:107], a[8:11], v[56:59]
    ds_read_b64_tr_b16 a[120:121], v10 offset:8192
    v_mfma_f32_16x16x32_bf16 v[56:59], a[108:111], a[12:15], v[56:59]
    ds_read_b128 a[228:231], v5 offset:20480
    v_exp_f32 v71, v71
    v_mfma_f32_16x16x32_bf16 a[188:191], a[196:199], v[88:91], a[188:191]
    ds_read_b64_tr_b16 a[124:125], v11 offset:8192
    v_cvt_pk_bf16_f32 v93, v70, v71
    v_mfma_f32_16x16x32_bf16 v[192:195], a[144:147], v[88:91], v[192:195]
    buffer_load_dwordx4 v20, s[20:23], s51 offen offset:2048 lds
    v_mfma_f32_16x16x32_bf16 v[196:199], a[148:151], v[88:91], v[196:199]
    ds_read_b128 a[232:235], v6 offset:20480
    v_exp_f32 v72, v72
    v_mfma_f32_16x16x32_bf16 v[200:203], a[152:155], v[88:91], v[200:203]
    ds_read_b128 a[236:239], v7 offset:20480
    v_exp_f32 v73, v73
    v_mfma_f32_16x16x32_bf16 v[204:207], a[156:159], v[88:91], v[204:207]
    ds_read_b64_tr_b16 a[128:129], v12 offset:8192
    v_cvt_pk_bf16_f32 v94, v72, v73
    v_mfma_f32_16x16x32_bf16 v[208:211], a[160:163], v[88:91], v[208:211]
    ds_read_b64_tr_b16 a[132:133], v13 offset:8192
    v_exp_f32 v74, v74
    v_mfma_f32_16x16x32_bf16 v[212:215], a[164:167], v[88:91], v[212:215]
    buffer_load_dwordx4 v21, s[20:23], s51 offen offset:3072 lds
    v_mfma_f32_16x16x32_bf16 v[216:219], a[168:171], v[88:91], v[216:219]
    v_exp_f32 v75, v75
    v_mfma_f32_16x16x32_bf16 v[220:223], a[172:175], v[88:91], v[220:223]
    s_waitcnt lgkmcnt(2)
    ds_read_b64_tr_b16 a[136:137], v14 offset:8192
    v_cvt_pk_bf16_f32 v95, v74, v75
    v_mfma_f32_16x16x32_bf16 v[60:63], a[208:211], a[0:3], v[32:35]
    v_exp_f32 v52, v52
    v_mfma_f32_16x16x32_bf16 v[60:63], a[212:215], a[4:7], v[60:63]
    ds_read_b64_tr_b16 a[140:141], v15 offset:8192
    v_mfma_f32_16x16x32_bf16 v[60:63], a[216:219], a[8:11], v[60:63]
    v_exp_f32 v53, v53
    v_mfma_f32_16x16x32_bf16 v[60:63], a[220:223], a[12:15], v[60:63]
    ds_read_b64_tr_b16 a[114:115], v8 offset:12288
    v_cvt_pk_bf16_f32 v76, v52, v53
    v_mfma_f32_16x16x32_bf16 v[64:67], a[224:227], a[0:3], v[32:35]
    v_exp_f32 v54, v54
    v_mfma_f32_16x16x32_bf16 v[64:67], a[228:231], a[4:7], v[64:67]
    v_exp_f32 v55, v55
    v_mfma_f32_16x16x32_bf16 v[64:67], a[232:235], a[8:11], v[64:67]
    ds_read_b64_tr_b16 a[118:119], v9 offset:12288
    v_cvt_pk_bf16_f32 v77, v54, v55
    v_mfma_f32_16x16x32_bf16 v[64:67], a[236:239], a[12:15], v[64:67]
    v_exp_f32 v56, v56
    v_mfma_f32_16x16x32_bf16 a[192:195], a[196:199], v[92:95], a[192:195]
    v_exp_f32 v57, v57
    v_mfma_f32_16x16x32_bf16 v[224:227], a[144:147], v[92:95], v[224:227]
    ds_read_b64_tr_b16 a[122:123], v10 offset:12288
    v_cvt_pk_bf16_f32 v78, v56, v57
    v_mfma_f32_16x16x32_bf16 v[228:231], a[148:151], v[92:95], v[228:231]
    v_exp_f32 v58, v58
    v_mfma_f32_16x16x32_bf16 v[232:235], a[152:155], v[92:95], v[232:235]
    ds_read_b64_tr_b16 a[126:127], v11 offset:12288
    v_mfma_f32_16x16x32_bf16 v[236:239], a[156:159], v[92:95], v[236:239]
    s_waitcnt vmcnt(4)
    ds_read_b64_tr_b16 a[144:145], v8 offset:24576
    v_mfma_f32_16x16x32_bf16 v[240:243], a[160:163], v[92:95], v[240:243]
    v_exp_f32 v59, v59
    v_mfma_f32_16x16x32_bf16 v[244:247], a[164:167], v[92:95], v[244:247]
    ds_read_b64_tr_b16 a[130:131], v12 offset:12288
    v_cvt_pk_bf16_f32 v79, v58, v59
    v_mfma_f32_16x16x32_bf16 v[248:251], a[168:171], v[92:95], v[248:251]
    ds_read_b64_tr_b16 a[148:149], v9 offset:24576
    v_mfma_f32_16x16x32_bf16 v[252:255], a[172:175], v[92:95], v[252:255]
    ds_read_b64_tr_b16 a[152:153], v10 offset:24576
    v_mfma_f32_16x16x32_bf16 v[68:71], a[80:83], a[16:19], v[36:39]
    ds_read_b64_tr_b16 a[134:135], v13 offset:12288
    v_exp_f32 v60, v60
    v_mfma_f32_16x16x32_bf16 v[68:71], a[84:87], a[20:23], v[68:71]
    ds_read_b64_tr_b16 a[138:139], v14 offset:12288
    v_mfma_f32_16x16x32_bf16 v[68:71], a[88:91], a[24:27], v[68:71]
    ds_read_b64_tr_b16 a[142:143], v15 offset:12288
    v_mfma_f32_16x16x32_bf16 v[68:71], a[92:95], a[28:31], v[68:71]
    ds_read_b64_tr_b16 a[156:157], v11 offset:24576
    v_exp_f32 v61, v61
    v_mfma_f32_16x16x32_bf16 v[72:75], a[96:99], a[16:19], v[36:39]
    ds_read_b64_tr_b16 a[160:161], v12 offset:24576
    v_cvt_pk_bf16_f32 v80, v60, v61
    v_mfma_f32_16x16x32_bf16 v[72:75], a[100:103], a[20:23], v[72:75]
    ds_read_b64_tr_b16 a[164:165], v13 offset:24576
    v_exp_f32 v62, v62
    v_mfma_f32_16x16x32_bf16 v[72:75], a[104:107], a[24:27], v[72:75]
    ds_read_b64_tr_b16 a[168:169], v14 offset:24576
    v_mfma_f32_16x16x32_bf16 v[72:75], a[108:111], a[28:31], v[72:75]
    s_waitcnt lgkmcnt(4)
    v_exp_f32 v63, v63
    v_mfma_f32_16x16x32_bf16 a[176:179], a[196:199], v[76:79], a[176:179]
    ds_read_b64_tr_b16 a[172:173], v15 offset:24576
    v_cvt_pk_bf16_f32 v81, v62, v63
    v_mfma_f32_16x16x32_bf16 v[96:99], a[112:115], v[76:79], v[96:99]
    s_waitcnt vmcnt(0)
    ds_read_b64_tr_b16 a[146:147], v8 offset:28672
    v_exp_f32 v64, v64
    v_mfma_f32_16x16x32_bf16 v[100:103], a[116:119], v[76:79], v[100:103]
    v_exp_f32 v65, v65
    v_mfma_f32_16x16x32_bf16 v[104:107], a[120:123], v[76:79], v[104:107]
    ds_read_b64_tr_b16 a[150:151], v9 offset:28672
    v_cvt_pk_bf16_f32 v82, v64, v65
    v_mfma_f32_16x16x32_bf16 v[108:111], a[124:127], v[76:79], v[108:111]
    v_exp_f32 v66, v66
    v_mfma_f32_16x16x32_bf16 v[112:115], a[128:131], v[76:79], v[112:115]
    ds_read_b64_tr_b16 a[154:155], v10 offset:28672
    v_mfma_f32_16x16x32_bf16 v[116:119], a[132:135], v[76:79], v[116:119]
    v_exp_f32 v67, v67
    v_mfma_f32_16x16x32_bf16 v[120:123], a[136:139], v[76:79], v[120:123]
    ds_read_b64_tr_b16 a[158:159], v11 offset:28672
    v_cvt_pk_bf16_f32 v83, v66, v67
    v_mfma_f32_16x16x32_bf16 v[124:127], a[140:143], v[76:79], v[124:127]
    ds_read_b64_tr_b16 a[162:163], v12 offset:28672
    v_mfma_f32_16x16x32_bf16 v[52:55], a[208:211], a[16:19], v[36:39]
    ds_read_b64_tr_b16 a[166:167], v13 offset:28672
    v_exp_f32 v68, v68
    v_mfma_f32_16x16x32_bf16 v[52:55], a[212:215], a[20:23], v[52:55]
    ds_read_b64_tr_b16 a[170:171], v14 offset:28672
    v_mfma_f32_16x16x32_bf16 v[52:55], a[216:219], a[24:27], v[52:55]
    ds_read_b64_tr_b16 a[174:175], v15 offset:28672
    v_mfma_f32_16x16x32_bf16 v[52:55], a[220:223], a[28:31], v[52:55]
    v_exp_f32 v69, v69
    v_mfma_f32_16x16x32_bf16 v[56:59], a[224:227], a[16:19], v[36:39]
    v_exp_f32 v70, v70
    v_mfma_f32_16x16x32_bf16 v[56:59], a[228:231], a[20:23], v[56:59]
    v_exp_f32 v71, v71
    v_mfma_f32_16x16x32_bf16 v[56:59], a[232:235], a[24:27], v[56:59]
    v_cvt_pk_bf16_f32 v84, v68, v69
    v_cvt_pk_bf16_f32 v85, v70, v71
    v_mfma_f32_16x16x32_bf16 v[56:59], a[236:239], a[28:31], v[56:59]
    s_waitcnt lgkmcnt(0)
    v_exp_f32 v72, v72
    v_mfma_f32_16x16x32_bf16 a[176:179], a[196:199], v[80:83], a[176:179]
    v_exp_f32 v73, v73
    v_mfma_f32_16x16x32_bf16 v[104:107], a[152:155], v[80:83], v[104:107]
    v_exp_f32 v74, v74
    v_mfma_f32_16x16x32_bf16 v[108:111], a[156:159], v[80:83], v[108:111]
    v_exp_f32 v75, v75
    v_mfma_f32_16x16x32_bf16 v[112:115], a[160:163], v[80:83], v[112:115]
    v_cvt_pk_bf16_f32 v86, v72, v73
    v_cvt_pk_bf16_f32 v87, v74, v75
    v_mfma_f32_16x16x32_bf16 v[116:119], a[164:167], v[80:83], v[116:119]
    v_exp_f32 v52, v52
    v_mfma_f32_16x16x32_bf16 v[120:123], a[168:171], v[80:83], v[120:123]
    v_exp_f32 v53, v53
    v_mfma_f32_16x16x32_bf16 v[124:127], a[172:175], v[80:83], v[124:127]
    ds_write_b32 v24, a176 offset:0
    v_cvt_pk_bf16_f32 v104, v104, v105
    v_mfma_f32_16x16x32_bf16 v[96:99], a[144:147], v[80:83], v[96:99]
    v_cvt_pk_bf16_f32 v105, v106, v107
    v_cvt_pk_bf16_f32 v106, v108, v109
    v_mfma_f32_16x16x32_bf16 v[100:103], a[148:151], v[80:83], v[100:103]
    v_cvt_pk_bf16_f32 v107, v110, v111
    v_cvt_pk_bf16_f32 v112, v112, v113
    v_mfma_f32_16x16x32_bf16 v[60:63], a[80:83], a[32:35], v[40:43]
    ds_write_b128 v25, v[104:107] offset:0
    v_mfma_f32_16x16x32_bf16 v[60:63], a[84:87], a[36:39], v[60:63]
    v_cvt_pk_bf16_f32 v113, v114, v115
    v_cvt_pk_bf16_f32 v114, v116, v117
    v_cvt_pk_bf16_f32 v115, v118, v119
    v_mfma_f32_16x16x32_bf16 v[60:63], a[88:91], a[40:43], v[60:63]
    ds_write_b128 v25, v[112:115] offset:5120
    v_mfma_f32_16x16x32_bf16 v[60:63], a[92:95], a[44:47], v[60:63]
    v_cvt_pk_bf16_f32 v120, v120, v121
    v_cvt_pk_bf16_f32 v121, v122, v123
    v_cvt_pk_bf16_f32 v122, v124, v125
    v_cvt_pk_bf16_f32 v123, v126, v127
    v_mfma_f32_16x16x32_bf16 v[64:67], a[96:99], a[32:35], v[40:43]
    ds_write_b128 v25, v[120:123] offset:10240
    v_mfma_f32_16x16x32_bf16 v[64:67], a[100:103], a[36:39], v[64:67]
    v_exp_f32 v54, v54
    v_mfma_f32_16x16x32_bf16 v[64:67], a[104:107], a[40:43], v[64:67]
    v_exp_f32 v55, v55
    v_mfma_f32_16x16x32_bf16 v[64:67], a[108:111], a[44:47], v[64:67]
L_hop3:
    s_cbranch_execz L_back
    v_cvt_pk_bf16_f32 v88, v52, v53
    v_cvt_pk_bf16_f32 v89, v54, v55
    v_mfma_f32_16x16x32_bf16 a[180:183], a[196:199], v[84:87], a[180:183]
    v_exp_f32 v56, v56
    v_mfma_f32_16x16x32_bf16 v[128:131], a[112:115], v[84:87], v[128:131]
    v_exp_f32 v57, v57
    v_mfma_f32_16x16x32_bf16 v[132:135], a[116:119], v[84:87], v[132:135]
    v_exp_f32 v58, v58
    v_mfma_f32_16x16x32_bf16 v[136:139], a[120:123], v[84:87], v[136:139]
    v_exp_f32 v59, v59
    v_mfma_f32_16x16x32_bf16 v[140:143], a[124:127], v[84:87], v[140:143]
    v_cvt_pk_bf16_f32 v90, v56, v57
    v_cvt_pk_bf16_f32 v91, v58, v59
    v_mfma_f32_16x16x32_bf16 v[144:147], a[128:131], v[84:87], v[144:147]
    v_exp_f32 v60, v60
    v_mfma_f32_16x16x32_bf16 v[148:151], a[132:135], v[84:87], v[148:151]
    v_exp_f32 v61, v61
    v_mfma_f32_16x16x32_bf16 v[152:155], a[136:139], v[84:87], v[152:155]
    v_exp_f32 v62, v62
    v_mfma_f32_16x16x32_bf16 v[156:159], a[140:143], v[84:87], v[156:159]
    v_exp_f32 v63, v63
    v_mfma_f32_16x16x32_bf16 v[68:71], a[208:211], a[32:35], v[40:43]
    v_cvt_pk_bf16_f32 v92, v60, v61
    v_cvt_pk_bf16_f32 v93, v62, v63
    v_mfma_f32_16x16x32_bf16 v[68:71], a[212:215], a[36:39], v[68:71]
    v_exp_f32 v64, v64
    v_mfma_f32_16x16x32_bf16 v[68:71], a[216:219], a[40:43], v[68:71]
    v_exp_f32 v65, v65
    v_mfma_f32_16x16x32_bf16 v[68:71], a[220:223], a[44:47], v[68:71]
    v_exp_f32 v66, v66
    v_mfma_f32_16x16x32_bf16 v[72:75], a[224:227], a[32:35], v[40:43]
    v_exp_f32 v67, v67
    v_mfma_f32_16x16x32_bf16 v[72:75], a[228:231], a[36:39], v[72:75]
    v_cvt_pk_bf16_f32 v94, v64, v65
    v_cvt_pk_bf16_f32 v95, v66, v67
    v_mfma_f32_16x16x32_bf16 v[72:75], a[232:235], a[40:43], v[72:75]
    v_mfma_f32_16x16x32_bf16 v[72:75], a[236:239], a[44:47], v[72:75]
    v_exp_f32 v68, v68
    v_mfma_f32_16x16x32_bf16 a[180:183], a[196:199], v[88:91], a[180:183]
    v_exp_f32 v69, v69
    v_mfma_f32_16x16x32_bf16 v[136:139], a[152:155], v[88:91], v[136:139]
    v_exp_f32 v70, v70
    v_mfma_f32_16x16x32_bf16 v[140:143], a[156:159], v[88:91], v[140:143]
    v_exp_f32 v71, v71
    v_mfma_f32_16x16x32_bf16 v[144:147], a[160:163], v[88:91], v[144:147]
    v_cvt_pk_bf16_f32 v76, v68, v69
    v_cvt_pk_bf16_f32 v77, v70, v71
    v_mfma_f32_16x16x32_bf16 v[148:151], a[164:167], v[88:91], v[148:151]
    v_exp_f32 v72, v72
    v_mfma_f32_16x16x32_bf16 v[152:155], a[168:171], v[88:91], v[152:155]
    v_exp_f32 v73, v73
    v_mfma_f32_16x16x32_bf16 v[156:159], a[172:175], v[88:91], v[156:159]
    ds_write_b32 v24, a180 offset:256
    v_cvt_pk_bf16_f32 v136, v136, v137
    v_mfma_f32_16x16x32_bf16 v[128:131], a[144:147], v[88:91], v[128:131]
    v_cvt_pk_bf16_f32 v137, v138, v139
    v_cvt_pk_bf16_f32 v138, v140, v141
    v_mfma_f32_16x16x32_bf16 v[132:135], a[148:151], v[88:91], v[132:135]
    v_cvt_pk_bf16_f32 v139, v142, v143
    v_cvt_pk_bf16_f32 v144, v144, v145
    v_mfma_f32_16x16x32_bf16 v[52:55], a[80:83], a[48:51], v[44:47]
    ds_write_b128 v25, v[136:139] offset:1024
    v_mfma_f32_16x16x32_bf16 v[52:55], a[84:87], a[52:55], v[52:55]
    v_cvt_pk_bf16_f32 v145, v146, v147
    v_cvt_pk_bf16_f32 v146, v148, v149
    v_cvt_pk_bf16_f32 v147, v150, v151
    v_mfma_f32_16x16x32_bf16 v[52:55], a[88:91], a[56:59], v[52:55]
    ds_write_b128 v25, v[144:147] offset:6144
    v_mfma_f32_16x16x32_bf16 v[52:55], a[92:95], a[60:63], v[52:55]
    v_cvt_pk_bf16_f32 v152, v152, v153
    v_cvt_pk_bf16_f32 v153, v154, v155
    v_cvt_pk_bf16_f32 v154, v156, v157
    v_cvt_pk_bf16_f32 v155, v158, v159
    v_mfma_f32_16x16x32_bf16 v[56:59], a[96:99], a[48:51], v[44:47]
    ds_write_b128 v25, v[152:155] offset:11264
    v_mfma_f32_16x16x32_bf16 v[56:59], a[100:103], a[52:55], v[56:59]
    v_exp_f32 v74, v74
    v_mfma_f32_16x16x32_bf16 v[56:59], a[104:107], a[56:59], v[56:59]
    v_exp_f32 v75, v75
    v_mfma_f32_16x16x32_bf16 v[56:59], a[108:111], a[60:63], v[56:59]
    v_cvt_pk_bf16_f32 v78, v72, v73
    v_cvt_pk_bf16_f32 v79, v74, v75
    v_mfma_f32_16x16x32_bf16 a[184:187], a[196:199], v[92:95], a[184:187]
    v_exp_f32 v52, v52
    v_mfma_f32_16x16x32_bf16 v[160:163], a[112:115], v[92:95], v[160:163]
    v_exp_f32 v53, v53
    v_mfma_f32_16x16x32_bf16 v[164:167], a[116:119], v[92:95], v[164:167]
    v_exp_f32 v54, v54
    v_mfma_f32_16x16x32_bf16 v[168:171], a[120:123], v[92:95], v[168:171]
    v_exp_f32 v55, v55
    s_waitcnt lgkmcnt(0)
    s_barrier
    ds_read_b128 a[0:3], v26 offset:0
    ds_read_b128 a[4:7], v27 offset:5120
    ds_read_b128 a[8:11], v28 offset:10240
    ds_read_b128 v[32:35], v23 offset:0
    v_mfma_f32_16x16x32_bf16 v[172:175], a[124:127], v[92:95], v[172:175]
    ds_read_b128 a[16:19], v26 offset:1024
    v_cvt_pk_bf16_f32 v80, v52, v53
    v_mfma_f32_16x16x32_bf16 v[176:179], a[128:131], v[92:95], v[176:179]
    ds_read_b128 a[20:23], v27 offset:6144
    v_cvt_pk_bf16_f32 v81, v54, v55
    v_mfma_f32_16x16x32_bf16 v[180:183], a[132:135], v[92:95], v[180:183]
    ds_read_b128 a[24:27], v28 offset:11264
    s_waitcnt lgkmcnt(3)
    v_add_f32 v32, v32, v33
    v_mfma_f32_16x16x32_bf16 v[184:187], a[136:139], v[92:95], v[184:187]
    v_exp_f32 v56, v56
    v_mfma_f32_16x16x32_bf16 v[188:191], a[140:143], v[92:95], v[188:191]
    ds_read_b128 v[36:39], v23 offset:256
    v_add_f32 v34, v34, v35
    v_mfma_f32_16x16x32_bf16 v[96:99], a[202:205], a[0:3], v[96:99]
    v_exp_f32 v57, v57
    v_mfma_f32_16x16x32_bf16 v[96:99], a[202:205], a[4:7], v[96:99]
    v_add_f32 v32, v32, v34
    v_cmp_ngt_f32 vcc, s61, v32
    v_mfma_f32_16x16x32_bf16 v[96:99], a[202:205], a[8:11], v[96:99]
    s_nop 0
    s_or_b64 s[8:9], s[8:9], vcc
    v_rcp_f32 v33, v32
    v_mfma_f32_16x16x32_bf16 v[100:103], a[200:203], a[0:3], v[100:103]
    v_cvt_pk_bf16_f32 v82, v56, v57
    s_waitcnt lgkmcnt(0)
    v_add_f32 v36, v36, v37
    v_mfma_f32_16x16x32_bf16 v[100:103], a[200:203], a[4:7], v[100:103]
    v_exp_f32 v58, v58
    v_mfma_f32_16x16x32_bf16 v[100:103], a[200:203], a[8:11], v[100:103]
    v_exp_f32 v59, v59
    v_mfma_f32_16x16x32_bf16 v[60:63], a[208:211], a[48:51], v[44:47]
    v_mul_f32 v96, v96, v33
    v_mul_f32 v97, v97, v33
    v_mfma_f32_16x16x32_bf16 v[60:63], a[212:215], a[52:55], v[60:63]
    v_mul_f32 v98, v98, v33
    v_mul_f32 v99, v99, v33
    v_mfma_f32_16x16x32_bf16 v[60:63], a[216:219], a[56:59], v[60:63]
    v_cvt_pk_bf16_f32 v104, v96, v97
    v_cvt_pk_bf16_f32 v105, v98, v99
    v_mfma_f32_16x16x32_bf16 v[60:63], a[220:223], a[60:63], v[60:63]
    v_mul_f32 v100, v100, v33
    v_mul_f32 v101, v101, v33
    v_mfma_f32_16x16x32_bf16 v[64:67], a[224:227], a[48:51], v[44:47]
    v_mul_f32 v102, v102, v33
    v_mul_f32 v103, v103, v33
    v_mfma_f32_16x16x32_bf16 v[64:67], a[228:231], a[52:55], v[64:67]
    v_cvt_pk_bf16_f32 v106, v100, v101
    v_cvt_pk_bf16_f32 v107, v102, v103
    v_mfma_f32_16x16x32_bf16 v[64:67], a[232:235], a[56:59], v[64:67]
    v_permlane16_swap_b32 v104, v106
    v_mfma_f32_16x16x32_bf16 v[64:67], a[236:239], a[60:63], v[64:67]
    v_permlane16_swap_b32 v105, v107
    v_mfma_f32_16x16x32_bf16 v[128:131], a[202:205], a[16:19], v[128:131]
    buffer_store_dwordx4 v[104:107], v29, s[24:27], s52 offen sc0 sc1
    v_mfma_f32_16x16x32_bf16 v[128:131], a[202:205], a[20:23], v[128:131]
    v_cvt_pk_bf16_f32 v83, v58, v59
    v_add_f32 v38, v38, v39
    v_mfma_f32_16x16x32_bf16 v[128:131], a[202:205], a[24:27], v[128:131]
    v_exp_f32 v60, v60
    v_mfma_f32_16x16x32_bf16 v[132:135], a[200:203], a[16:19], v[132:135]
    v_exp_f32 v61, v61
    v_mfma_f32_16x16x32_bf16 v[132:135], a[200:203], a[20:23], v[132:135]
    v_add_f32 v36, v36, v38
    v_cmp_ngt_f32 vcc, s61, v36
    v_mfma_f32_16x16x32_bf16 v[132:135], a[200:203], a[24:27], v[132:135]
    s_nop 0
    s_or_b64 s[8:9], s[8:9], vcc
    v_rcp_f32 v37, v36
    v_mfma_f32_16x16x32_bf16 a[184:187], a[196:199], v[76:79], a[184:187]
    v_mul_f32 v128, v128, v37
    v_mul_f32 v129, v129, v37
    v_mfma_f32_16x16x32_bf16 v[168:171], a[152:155], v[76:79], v[168:171]
    v_mul_f32 v130, v130, v37
    v_mul_f32 v131, v131, v37
    v_mfma_f32_16x16x32_bf16 v[172:175], a[156:159], v[76:79], v[172:175]
    v_cvt_pk_bf16_f32 v136, v128, v129
    v_cvt_pk_bf16_f32 v137, v130, v131
    v_mfma_f32_16x16x32_bf16 v[176:179], a[160:163], v[76:79], v[176:179]
    v_mul_f32 v132, v132, v37
    v_mul_f32 v133, v133, v37
    v_mfma_f32_16x16x32_bf16 v[180:183], a[164:167], v[76:79], v[180:183]
    ds_write_b32 v24, a184 offset:512
    v_mul_f32 v134, v134, v37
    v_mfma_f32_16x16x32_bf16 v[184:187], a[168:171], v[76:79], v[184:187]
    v_mul_f32 v135, v135, v37
    v_cvt_pk_bf16_f32 v138, v132, v133
    v_mfma_f32_16x16x32_bf16 v[188:191], a[172:175], v[76:79], v[188:191]
    v_cvt_pk_bf16_f32 v168, v168, v169
    v_cvt_pk_bf16_f32 v169, v170, v171
    v_mfma_f32_16x16x32_bf16 v[160:163], a[144:147], v[76:79], v[160:163]
    v_cvt_pk_bf16_f32 v170, v172, v173
    v_cvt_pk_bf16_f32 v171, v174, v175
    v_mfma_f32_16x16x32_bf16 v[164:167], a[148:151], v[76:79], v[164:167]
    ds_write_b128 v25, v[168:171] offset:2048
    v_mfma_f32_16x16x32_bf16 v[68:71], a[80:83], a[64:67], v[48:51]
    v_cvt_pk_bf16_f32 v139, v134, v135
    v_cvt_pk_bf16_f32 v176, v176, v177
    v_mfma_f32_16x16x32_bf16 v[68:71], a[84:87], a[68:71], v[68:71]
    v_cvt_pk_bf16_f32 v177, v178, v179
    v_cvt_pk_bf16_f32 v178, v180, v181
    v_cvt_pk_bf16_f32 v179, v182, v183
    v_mfma_f32_16x16x32_bf16 v[68:71], a[88:91], a[72:75], v[68:71]
    ds_write_b128 v25, v[176:179] offset:7168
    v_permlane16_swap_b32 v136, v138
    v_permlane16_swap_b32 v137, v139
    buffer_store_dwordx4 v[136:139], v29, s[24:27], s53 offen sc0 sc1
    v_mfma_f32_16x16x32_bf16 v[68:71], a[92:95], a[76:79], v[68:71]
    v_cvt_pk_bf16_f32 v184, v184, v185
    v_cvt_pk_bf16_f32 v185, v186, v187
    v_cvt_pk_bf16_f32 v186, v188, v189
    v_cvt_pk_bf16_f32 v187, v190, v191
    v_mfma_f32_16x16x32_bf16 v[72:75], a[96:99], a[64:67], v[48:51]
    ds_write_b128 v25, v[184:187] offset:12288
    v_mfma_f32_16x16x32_bf16 v[72:75], a[100:103], a[68:71], v[72:75]
    v_exp_f32 v62, v62
    v_mfma_f32_16x16x32_bf16 v[72:75], a[104:107], a[72:75], v[72:75]
    v_exp_f32 v63, v63
    v_mfma_f32_16x16x32_bf16 v[72:75], a[108:111], a[76:79], v[72:75]
    v_cvt_pk_bf16_f32 v84, v60, v61
    v_cvt_pk_bf16_f32 v85, v62, v63
    v_mfma_f32_16x16x32_bf16 a[188:191], a[196:199], v[80:83], a[188:191]
    v_exp_f32 v64, v64
    v_mfma_f32_16x16x32_bf16 v[192:195], a[112:115], v[80:83], v[192:195]
    v_exp_f32 v65, v65
    v_mfma_f32_16x16x32_bf16 v[196:199], a[116:119], v[80:83], v[196:199]
    v_exp_f32 v66, v66
    v_mfma_f32_16x16x32_bf16 v[200:203], a[120:123], v[80:83], v[200:203]
    v_exp_f32 v67, v67
    v_mfma_f32_16x16x32_bf16 v[204:207], a[124:127], v[80:83], v[204:207]
    v_cvt_pk_bf16_f32 v86, v64, v65
    v_cvt_pk_bf16_f32 v87, v66, v67
    v_mfma_f32_16x16x32_bf16 v[208:211], a[128:131], v[80:83], v[208:211]
    v_exp_f32 v68, v68
    v_mfma_f32_16x16x32_bf16 v[212:215], a[132:135], v[80:83], v[212:215]
    v_exp_f32 v69, v69
    v_mfma_f32_16x16x32_bf16 v[216:219], a[136:139], v[80:83], v[216:219]
    v_exp_f32 v70, v70
    v_mfma_f32_16x16x32_bf16 v[220:223], a[140:143], v[80:83], v[220:223]
    v_exp_f32 v71, v71
    v_mfma_f32_16x16x32_bf16 a[188:191], a[196:199], v[84:87], a[188:191]
    v_cvt_pk_bf16_f32 v88, v68, v69
    v_cvt_pk_bf16_f32 v89, v70, v71
    v_mfma_f32_16x16x32_bf16 v[200:203], a[152:155], v[84:87], v[200:203]
    v_exp_f32 v72, v72
    v_mfma_f32_16x16x32_bf16 v[204:207], a[156:159], v[84:87], v[204:207]
    v_exp_f32 v73, v73
    v_mfma_f32_16x16x32_bf16 v[208:211], a[160:163], v[84:87], v[208:211]
    v_exp_f32 v74, v74
    v_mfma_f32_16x16x32_bf16 v[212:215], a[164:167], v[84:87], v[212:215]
    ds_write_b32 v24, a188 offset:768
    v_cvt_pk_bf16_f32 v90, v72, v73
    v_mfma_f32_16x16x32_bf16 v[216:219], a[168:171], v[84:87], v[216:219]
    v_exp_f32 v75, v75
    v_mfma_f32_16x16x32_bf16 v[220:223], a[172:175], v[84:87], v[220:223]
    v_cvt_pk_bf16_f32 v200, v200, v201
    v_cvt_pk_bf16_f32 v201, v202, v203
    v_mfma_f32_16x16x32_bf16 v[192:195], a[144:147], v[84:87], v[192:195]
    v_cvt_pk_bf16_f32 v202, v204, v205
    v_cvt_pk_bf16_f32 v203, v206, v207
    v_mfma_f32_16x16x32_bf16 v[196:199], a[148:151], v[84:87], v[196:199]
    ds_write_b128 v25, v[200:203] offset:3072
    v_mfma_f32_16x16x32_bf16 v[52:55], a[208:211], a[64:67], v[48:51]
    v_cvt_pk_bf16_f32 v208, v208, v209
    v_cvt_pk_bf16_f32 v209, v210, v211
    v_mfma_f32_16x16x32_bf16 v[52:55], a[212:215], a[68:71], v[52:55]
    v_cvt_pk_bf16_f32 v210, v212, v213
    v_cvt_pk_bf16_f32 v211, v214, v215
    v_mfma_f32_16x16x32_bf16 v[52:55], a[216:219], a[72:75], v[52:55]
    ds_write_b128 v25, v[208:211] offset:8192
    v_mfma_f32_16x16x32_bf16 v[52:55], a[220:223], a[76:79], v[52:55]
    v_cvt_pk_bf16_f32 v216, v216, v217
    v_cvt_pk_bf16_f32 v217, v218, v219
    v_cvt_pk_bf16_f32 v218, v220, v221
    v_cvt_pk_bf16_f32 v219, v222, v223
    v_mfma_f32_16x16x32_bf16 v[56:59], a[224:227], a[64:67], v[48:51]
    ds_write_b128 v25, v[216:219] offset:13312
    v_mfma_f32_16x16x32_bf16 v[56:59], a[228:231], a[68:71], v[56:59]
    v_cvt_pk_bf16_f32 v91, v74, v75
    v_mfma_f32_16x16x32_bf16 v[56:59], a[232:235], a[72:75], v[56:59]
    v_mfma_f32_16x16x32_bf16 v[56:59], a[236:239], a[76:79], v[56:59]
    v_exp_f32 v52, v52
    v_mfma_f32_16x16x32_bf16 a[192:195], a[196:199], v[88:91], a[192:195]
    v_exp_f32 v53, v53
    v_mfma_f32_16x16x32_bf16 v[224:227], a[112:115], v[88:91], v[224:227]
    v_exp_f32 v54, v54
    s_waitcnt lgkmcnt(0)
    s_barrier
    v_cvt_pk_bf16_f32 v92, v52, v53
    ds_read_b128 a[32:35], v26 offset:2048
    v_mfma_f32_16x16x32_bf16 v[228:231], a[116:119], v[88:91], v[228:231]
    v_exp_f32 v55, v55
    v_mfma_f32_16x16x32_bf16 v[232:235], a[120:123], v[88:91], v[232:235]
    ds_read_b128 a[36:39], v27 offset:7168
    ds_read_b128 a[40:43], v28 offset:12288
    v_mfma_f32_16x16x32_bf16 v[236:239], a[124:127], v[88:91], v[236:239]
    v_exp_f32 v56, v56
    v_mfma_f32_16x16x32_bf16 v[240:243], a[128:131], v[88:91], v[240:243]
    ds_read_b128 v[40:43], v23 offset:512
    v_cvt_pk_bf16_f32 v93, v54, v55
    v_mfma_f32_16x16x32_bf16 v[244:247], a[132:135], v[88:91], v[244:247]
    v_exp_f32 v57, v57
    v_mfma_f32_16x16x32_bf16 v[248:251], a[136:139], v[88:91], v[248:251]
    ds_read_b128 a[48:51], v26 offset:3072
    v_cvt_pk_bf16_f32 v94, v56, v57
    v_mfma_f32_16x16x32_bf16 v[252:255], a[140:143], v[88:91], v[252:255]
    ds_read_b128 a[52:55], v27 offset:8192
    s_waitcnt lgkmcnt(2)
    v_add_f32 v40, v40, v41
    v_mfma_f32_16x16x32_bf16 v[160:163], a[202:205], a[32:35], v[160:163]
    ds_read_b128 a[56:59], v28 offset:13312
    v_add_f32 v42, v42, v43
    v_mfma_f32_16x16x32_bf16 v[160:163], a[202:205], a[36:39], v[160:163]
    v_exp_f32 v58, v58
    v_mfma_f32_16x16x32_bf16 v[160:163], a[202:205], a[40:43], v[160:163]
    ds_read_b128 v[44:47], v23 offset:768
    v_add_f32 v40, v40, v42
    v_mfma_f32_16x16x32_bf16 v[164:167], a[200:203], a[32:35], v[164:167]
    v_exp_f32 v59, v59
    v_mfma_f32_16x16x32_bf16 v[164:167], a[200:203], a[36:39], v[164:167]
    v_cvt_pk_bf16_f32 v95, v58, v59
    v_cmp_ngt_f32 vcc, s61, v40
    v_mfma_f32_16x16x32_bf16 v[164:167], a[200:203], a[40:43], v[164:167]
    s_nop 0
    s_or_b64 s[8:9], s[8:9], vcc
    v_rcp_f32 v41, v40
    s_waitcnt lgkmcnt(3)
    v_mfma_f32_16x16x32_bf16 v[192:195], a[202:205], a[48:51], v[192:195]
    v_mul_f32 v160, v160, v41
    v_mul_f32 v161, v161, v41
    s_waitcnt lgkmcnt(2)
    v_mfma_f32_16x16x32_bf16 v[192:195], a[202:205], a[52:55], v[192:195]
    v_mul_f32 v162, v162, v41
    v_mul_f32 v163, v163, v41
    s_waitcnt lgkmcnt(1)
    v_mfma_f32_16x16x32_bf16 v[192:195], a[202:205], a[56:59], v[192:195]
    v_cvt_pk_bf16_f32 v168, v160, v161
    v_cvt_pk_bf16_f32 v169, v162, v163
    v_mfma_f32_16x16x32_bf16 v[196:199], a[200:203], a[48:51], v[196:199]
    v_mul_f32 v164, v164, v41
    v_mul_f32 v165, v165, v41
    v_mfma_f32_16x16x32_bf16 v[196:199], a[200:203], a[52:55], v[196:199]
    v_mul_f32 v166, v166, v41
    v_mul_f32 v167, v167, v41
    v_mfma_f32_16x16x32_bf16 v[196:199], a[200:203], a[56:59], v[196:199]
    v_cvt_pk_bf16_f32 v170, v164, v165
    v_cvt_pk_bf16_f32 v171, v166, v167
    v_mfma_f32_16x16x32_bf16 a[192:195], a[196:199], v[92:95], a[192:195]
    v_permlane16_swap_b32 v168, v170
    v_mfma_f32_16x16x32_bf16 v[232:235], a[152:155], v[92:95], v[232:235]
    v_permlane16_swap_b32 v169, v171
    v_mfma_f32_16x16x32_bf16 v[236:239], a[156:159], v[92:95], v[236:239]
    buffer_store_dwordx4 v[168:171], v29, s[24:27], s54 offen sc0 sc1
    v_mfma_f32_16x16x32_bf16 v[240:243], a[160:163], v[92:95], v[240:243]
    s_waitcnt lgkmcnt(0)
    v_add_f32 v44, v44, v45
    v_add_f32 v46, v46, v47
    v_mfma_f32_16x16x32_bf16 v[244:247], a[164:167], v[92:95], v[244:247]
    ds_write_b32 v24, a192 offset:1024
    v_add_f32 v44, v44, v46
    v_mfma_f32_16x16x32_bf16 v[248:251], a[168:171], v[92:95], v[248:251]
    v_rcp_f32 v45, v44
    v_mfma_f32_16x16x32_bf16 v[252:255], a[172:175], v[92:95], v[252:255]
    v_cvt_pk_bf16_f32 v232, v232, v233
    v_cvt_pk_bf16_f32 v233, v234, v235
    v_mfma_f32_16x16x32_bf16 v[224:227], a[144:147], v[92:95], v[224:227]
    v_cvt_pk_bf16_f32 v234, v236, v237
    v_cvt_pk_bf16_f32 v235, v238, v239
    v_mfma_f32_16x16x32_bf16 v[228:231], a[148:151], v[92:95], v[228:231]
    ds_write_b128 v25, v[232:235] offset:4096
    v_mul_f32 v192, v192, v45
    v_mul_f32 v193, v193, v45
    v_mul_f32 v194, v194, v45
    v_mul_f32 v195, v195, v45
    v_cvt_pk_bf16_f32 v200, v192, v193
    v_cvt_pk_bf16_f32 v201, v194, v195
    v_mul_f32 v196, v196, v45
    v_mul_f32 v197, v197, v45
    v_mul_f32 v198, v198, v45
    v_mul_f32 v199, v199, v45
    v_cvt_pk_bf16_f32 v202, v196, v197
    v_cvt_pk_bf16_f32 v203, v198, v199
    v_cvt_pk_bf16_f32 v240, v240, v241
    v_cvt_pk_bf16_f32 v241, v242, v243
    v_cvt_pk_bf16_f32 v242, v244, v245
    v_cvt_pk_bf16_f32 v243, v246, v247
    ds_write_b128 v25, v[240:243] offset:9216
    v_permlane16_swap_b32 v200, v202
    v_permlane16_swap_b32 v201, v203
    buffer_store_dwordx4 v[200:203], v29, s[24:27], s55 offen sc0 sc1
    v_cvt_pk_bf16_f32 v248, v248, v249
    v_cvt_pk_bf16_f32 v249, v250, v251
    v_cvt_pk_bf16_f32 v250, v252, v253
    v_cvt_pk_bf16_f32 v251, v254, v255
    ds_write_b128 v25, v[248:251] offset:14336
    v_cmp_ngt_f32 vcc, s61, v44
    s_nop 1
    s_or_b64 s[8:9], s[8:9], vcc
    s_waitcnt lgkmcnt(0)
    s_barrier
    ds_read_b128 a[64:67], v26 offset:4096
    ds_read_b128 a[68:71], v27 offset:9216
    ds_read_b128 a[72:75], v28 offset:14336
    ds_read_b128 v[48:51], v23 offset:1024
    s_waitcnt lgkmcnt(3)
    v_mfma_f32_16x16x32_bf16 v[224:227], a[202:205], a[64:67], v[224:227]
    s_waitcnt lgkmcnt(0)
    v_add_f32 v48, v48, v49
    v_add_f32 v50, v50, v51
    v_mfma_f32_16x16x32_bf16 v[224:227], a[202:205], a[68:71], v[224:227]
    v_add_f32 v48, v48, v50
    v_cmp_ngt_f32 vcc, s61, v48
    v_mfma_f32_16x16x32_bf16 v[224:227], a[202:205], a[72:75], v[224:227]
    s_nop 0
    s_or_b64 s[8:9], s[8:9], vcc
    v_rcp_f32 v49, v48
    v_mfma_f32_16x16x32_bf16 v[228:231], a[200:203], a[64:67], v[228:231]
    v_mfma_f32_16x16x32_bf16 v[228:231], a[200:203], a[68:71], v[228:231]
    v_mfma_f32_16x16x32_bf16 v[228:231], a[200:203], a[72:75], v[228:231]
    s_nop 1
    v_mul_f32 v224, v224, v49
    v_mul_f32 v225, v225, v49
    v_mul_f32 v226, v226, v49
    v_mul_f32 v227, v227, v49
    v_cvt_pk_bf16_f32 v232, v224, v225
    v_cvt_pk_bf16_f32 v233, v226, v227
    v_mul_f32 v228, v228, v49
    v_mul_f32 v229, v229, v49
    v_mul_f32 v230, v230, v49
    v_mul_f32 v231, v231, v49
    v_cvt_pk_bf16_f32 v234, v228, v229
    v_cvt_pk_bf16_f32 v235, v230, v231
    s_nop 0
    v_permlane16_swap_b32 v232, v234
    v_permlane16_swap_b32 v233, v235
    buffer_store_dwordx4 v[232:235], v29, s[24:27], s56 offen sc0 sc1
    s_cmp_lg_u64 s[8:9], 0
    s_cbranch_scc1 L_fallback
L_done:
L_end:
    s_endpgm
L_fallback:
    s_cmp_lg_u32 s60, 0
    s_cbranch_scc1 L_done
    s_mov_b32 s60, 1
    s_waitcnt vmcnt(0) lgkmcnt(0)
    s_barrier
    v_add_u32 v176, s34, v4
    v_add_u32 v177, s34, v5
    v_add_u32 v178, s34, v6
    v_add_u32 v179, s34, v7
    s_mov_b64 s[8:9], 0
    ds_read_b128 a[0:3], v176 offset:0
    ds_read_b128 a[4:7], v177 offset:0
    ds_read_b128 a[8:11], v178 offset:0
    ds_read_b128 a[12:15], v179 offset:0
    ds_read_b128 a[16:19], v176 offset:4096
    ds_read_b128 a[20:23], v177 offset:4096
    ds_read_b128 a[24:27], v178 offset:4096
    ds_read_b128 a[28:31], v179 offset:4096
    ds_read_b128 a[32:35], v176 offset:8192
    ds_read_b128 a[36:39], v177 offset:8192
    ds_read_b128 a[40:43], v178 offset:8192
    ds_read_b128 a[44:47], v179 offset:8192
    ds_read_b128 a[48:51], v176 offset:12288
    ds_read_b128 a[52:55], v177 offset:12288
    ds_read_b128 a[56:59], v178 offset:12288
    ds_read_b128 a[60:63], v179 offset:12288
    ds_read_b128 a[64:67], v176 offset:16384
    ds_read_b128 a[68:71], v177 offset:16384
    ds_read_b128 a[72:75], v178 offset:16384
    ds_read_b128 a[76:79], v179 offset:16384
    v_mov_b32 v100, 0xff800000
    v_mov_b32 v132, 0xff800000
    v_mov_b32 v164, 0xff800000
    v_mov_b32 v196, 0xff800000
    v_mov_b32 v228, 0xff800000
    s_waitcnt lgkmcnt(0)
    s_mov_b32 s62, s35
    s_mov_b32 s63, 0
L_fb_loop:
    s_nop 7
    s_mov_b32 m0, s31
    s_nop 0
    buffer_load_dwordx4 v16, s[16:19], s62 offen lds
    buffer_load_dwordx4 v17, s[16:19], s62 offen offset:1024 lds
    buffer_load_dwordx4 v18, s[16:19], s62 offen offset:2048 lds
    buffer_load_dwordx4 v19, s[16:19], s62 offen offset:3072 lds
    s_add_u32 s62, s62, 4096
    s_waitcnt vmcnt(0)
    ds_read_b128 a[80:83], v4 offset:0
    ds_read_b128 a[84:87], v5 offset:0
    ds_read_b128 a[88:91], v6 offset:0
    ds_read_b128 a[92:95], v7 offset:0
    s_waitcnt lgkmcnt(3)
    v_mfma_f32_16x16x32_bf16 v[96:99], a[80:83], a[0:3], 0
    s_waitcnt lgkmcnt(2)
    v_mfma_f32_16x16x32_bf16 v[96:99], a[84:87], a[4:7], v[96:99]
    s_waitcnt lgkmcnt(1)
    v_mfma_f32_16x16x32_bf16 v[96:99], a[88:91], a[8:11], v[96:99]
    s_waitcnt lgkmcnt(0)
    v_mfma_f32_16x16x32_bf16 v[96:99], a[92:95], a[12:15], v[96:99]
    v_mfma_f32_16x16x32_bf16 v[128:131], a[80:83], a[16:19], 0
    v_mfma_f32_16x16x32_bf16 v[128:131], a[84:87], a[20:23], v[128:131]
    v_mfma_f32_16x16x32_bf16 v[128:131], a[88:91], a[24:27], v[128:131]
    v_mfma_f32_16x16x32_bf16 v[128:131], a[92:95], a[28:31], v[128:131]
    v_mfma_f32_16x16x32_bf16 v[160:163], a[80:83], a[32:35], 0
    v_mfma_f32_16x16x32_bf16 v[160:163], a[84:87], a[36:39], v[160:163]
    v_mfma_f32_16x16x32_bf16 v[160:163], a[88:91], a[40:43], v[160:163]
    v_mfma_f32_16x16x32_bf16 v[160:163], a[92:95], a[44:47], v[160:163]
    v_mfma_f32_16x16x32_bf16 v[192:195], a[80:83], a[48:51], 0
    v_mfma_f32_16x16x32_bf16 v[192:195], a[84:87], a[52:55], v[192:195]
    v_mfma_f32_16x16x32_bf16 v[192:195], a[88:91], a[56:59], v[192:195]
    v_mfma_f32_16x16x32_bf16 v[192:195], a[92:95], a[60:63], v[192:195]
    v_mfma_f32_16x16x32_bf16 v[224:227], a[80:83], a[64:67], 0
    v_mfma_f32_16x16x32_bf16 v[224:227], a[84:87], a[68:71], v[224:227]
    v_mfma_f32_16x16x32_bf16 v[224:227], a[88:91], a[72:75], v[224:227]
    v_mfma_f32_16x16x32_bf16 v[224:227], a[92:95], a[76:79], v[224:227]
    v_max3_f32 v100, v100, v96, v97
    v_max3_f32 v100, v100, v98, v99
    v_max3_f32 v132, v132, v128, v129
    v_max3_f32 v132, v132, v130, v131
    v_max3_f32 v164, v164, v160, v161
    v_max3_f32 v164, v164, v162, v163
    v_max3_f32 v196, v196, v192, v193
    v_max3_f32 v196, v196, v194, v195
    v_max3_f32 v228, v228, v224, v225
    v_max3_f32 v228, v228, v226, v227
    s_add_u32 s63, s63, 1
    s_cmp_lt_u32 s63, 16
    s_cbranch_scc1 L_fb_loop
    ds_max_f32 v22, v100 offset:0
    ds_max_f32 v22, v132 offset:64
    ds_max_f32 v22, v164 offset:128
    ds_max_f32 v22, v196 offset:192
    ds_max_f32 v22, v228 offset:256
    s_waitcnt lgkmcnt(0)
    s_mov_b32 m0, s31
    s_nop 0
    buffer_load_dwordx4 v16, s[16:19], s36 offen lds
    buffer_load_dwordx4 v17, s[16:19], s36 offen offset:1024 lds
    buffer_load_dwordx4 v18, s[16:19], s36 offen offset:2048 lds
    buffer_load_dwordx4 v19, s[16:19], s36 offen offset:3072 lds
    s_add_u32 m0, s31, 4096
    s_nop 0
    buffer_load_dwordx4 v16, s[16:19], s37 offen lds
    buffer_load_dwordx4 v17, s[16:19], s37 offen offset:1024 lds
    buffer_load_dwordx4 v18, s[16:19], s37 offen offset:2048 lds
    buffer_load_dwordx4 v19, s[16:19], s37 offen offset:3072 lds
    s_add_u32 m0, s31, 8192
    s_nop 0
    buffer_load_dwordx4 v20, s[20:23], s36 offen lds
    buffer_load_dwordx4 v21, s[20:23], s36 offen offset:1024 lds
    buffer_load_dwordx4 v20, s[20:23], s36 offen offset:2048 lds
    buffer_load_dwordx4 v21, s[20:23], s36 offen offset:3072 lds
    s_add_u32 m0, s31, 12288
    s_nop 0
    buffer_load_dwordx4 v20, s[20:23], s37 offen lds
    buffer_load_dwordx4 v21, s[20:23], s37 offen offset:1024 lds
    s_waitcnt vmcnt(0)
    s_add_u32 m0, s31, 12288
    ds_read_b128 a[80:83], v4 offset:0
    ds_read_b128 a[84:87], v5 offset:0
    ds_read_b128 a[88:91], v6 offset:0
    ds_read_b128 a[92:95], v7 offset:0
    s_waitcnt lgkmcnt(3)
    v_mfma_f32_16x16x32_bf16 v[96:99], a[80:83], a[0:3], 0
    s_waitcnt lgkmcnt(2)
    v_mfma_f32_16x16x32_bf16 v[96:99], a[84:87], a[4:7], v[96:99]
    s_waitcnt lgkmcnt(1)
    v_mfma_f32_16x16x32_bf16 v[96:99], a[88:91], a[8:11], v[96:99]
    s_waitcnt lgkmcnt(0)
    v_mfma_f32_16x16x32_bf16 v[96:99], a[92:95], a[12:15], v[96:99]
    v_mfma_f32_16x16x32_bf16 v[128:131], a[80:83], a[16:19], 0
    v_mfma_f32_16x16x32_bf16 v[128:131], a[84:87], a[20:23], v[128:131]
    v_mfma_f32_16x16x32_bf16 v[128:131], a[88:91], a[24:27], v[128:131]
    v_mfma_f32_16x16x32_bf16 v[128:131], a[92:95], a[28:31], v[128:131]
    v_mfma_f32_16x16x32_bf16 v[160:163], a[80:83], a[32:35], 0
    v_mfma_f32_16x16x32_bf16 v[160:163], a[84:87], a[36:39], v[160:163]
    v_mfma_f32_16x16x32_bf16 v[160:163], a[88:91], a[40:43], v[160:163]
    v_mfma_f32_16x16x32_bf16 v[160:163], a[92:95], a[44:47], v[160:163]
    s_nop 7
    s_branch L_restart
.section .rodata,"a"
.p2align 6
.amdhsa_kernel standalone__gqa_softmax__near_ridge_kernel
  .amdhsa_next_free_vgpr 496
  .amdhsa_next_free_sgpr 102
  .amdhsa_accum_offset 256
  .amdhsa_group_segment_fixed_size 0
  .amdhsa_kernarg_size 48
  .amdhsa_user_sgpr_count 2
  .amdhsa_user_sgpr_kernarg_segment_ptr 1
  .amdhsa_system_sgpr_workgroup_id_x 1
.end_amdhsa_kernel
```
